```python
import torch

def _softmax(x, axis=-1):
    return torch.softmax(x, dim=axis)
def _gelu(x):
    return torch.nn.functional.gelu(x, approximate="tanh")
def _silu(x):
    return torch.nn.functional.silu(x)
def _sigmoid(x):
    return torch.sigmoid(x)
def _layernorm(x, axis=-1, eps=1e-5):
    m = x.mean(dim=axis, keepdim=True)
    v = x.var(dim=axis, keepdim=True, unbiased=False)
    return (x - m) / torch.sqrt(v + eps)
def _scatter_add(tgt, idx, src, axis=0):
    return tgt.clone().index_add_(axis, idx, src)
def _segment_sum(src, seg, n):
    out = torch.zeros((n,) + src.shape[1:], dtype=src.dtype)
    return out.index_add_(0, seg, src)
def _pad(x, pw):
    flat = tuple(v for pair in reversed(pw) for v in pair)
    return torch.nn.functional.pad(x, flat)

kernel_name = 'sequential_preLN__ssm_conv_h3__moe_arch_mod__prompt'

def setup_inputs():

    _w = (lambda a: (lambda t: t.to(torch.bfloat16) if t.is_floating_point() else t)(torch.as_tensor(a)))
    def _A_setup():
        B, S, D = 1, 2048, 640
        ks = 4
        return {
            "q": _w((lambda *s: torch.randn(*s, dtype=torch.bfloat16) * 0.05)(B, S, D)),
            "k": _w((lambda *s: torch.randn(*s, dtype=torch.bfloat16) * 0.2)(B, S, D)),
            "v": _w((lambda *s: torch.randn(*s, dtype=torch.bfloat16) * 0.2)(B, S, D)),
            "shift_k": _w((lambda *s: torch.randn(*s, dtype=torch.bfloat16) * 0.2)(D, ks) * 0.5),
            "ssm_k": _w((lambda *s: torch.randn(*s, dtype=torch.bfloat16) * 0.8)(D, S) * (1.0 / S ** 0.5)),
            "ssm_D": _w((lambda *s: torch.randn(*s, dtype=torch.bfloat16) * 0.2)(D)),
        }
    _A_in = _A_setup()

    def _B_setup():
        B, S, D, F, C = 1, 2048, 640, 1536, 2
        return {
            "x": _w((lambda *s: torch.randn(*s, dtype=torch.bfloat16) * 0.05)(B, S, D)),
            "w_r": _w((lambda *s: torch.randn(*s, dtype=torch.bfloat16) * 0.05)(D)),
            "w_gate": _w((lambda *s: torch.randn(*s, dtype=torch.bfloat16) * 0.05)(D, F)),
            "w_up": _w((lambda *s: torch.randn(*s, dtype=torch.bfloat16) * 0.05)(D, F)),
            "w_down": _w((lambda *s: torch.randn(*s, dtype=torch.bfloat16) * 0.05)(F, D)),
        }
    _B_in = _B_setup()

    return {
        "A_q": _A_in["q"],
        "A_k": _A_in["k"],
        "A_v": _A_in["v"],
        "A_shift_k": _A_in["shift_k"],
        "A_ssm_k": _A_in["ssm_k"],
        "A_ssm_D": _A_in["ssm_D"],
        "B_x": _B_in["x"],
        "B_w_r": _B_in["w_r"],
        "B_w_gate": _B_in["w_gate"],
        "B_w_up": _B_in["w_up"],
        "B_w_down": _B_in["w_down"],
    }

def reference(A_q, A_k, A_v, A_shift_k, A_ssm_k, A_ssm_D, B_x, B_w_r, B_w_gate, B_w_up, B_w_down):
    def _A_ref(q, k, v, shift_k, ssm_k, ssm_D):
        B, S, D = q.shape
        ks = shift_k.shape[-1]
        k_pad = _pad(k, ((0, 0), (ks - 1, 0), (0, 0)))
        k_shift = torch.zeros_like(k)
        for t in range(ks):
            k_shift = k_shift + k_pad[:, t:t + S, :] * shift_k[:, ks - 1 - t][None, None, :]
        kv = k_shift * v
        L = 2 * S
        kv_pad = _pad(kv, ((0, 0), (0, S), (0, 0)))
        kf_pad = _pad(ssm_k, ((0, 0), (0, S)))
        kv_f = (lambda x, axes=(-2,-1): torch.fft.rfft2(x.float(), dim=axes))(kv_pad[:, None, :, :], axes=(1, 2))
        kf_f = (lambda x, axes=(-2,-1): torch.fft.rfft2(x.float(), dim=axes))(kf_pad[:, None, :], axes=(1, 2))
        kf_f = (lambda x, *d: x.permute(*d))(kf_f, 1, 2, 0)
        y_f = kv_f * kf_f[None, :, :, :]
        y = (lambda x, s, axes=(-2,-1): torch.fft.irfft2(x, s=s, dim=axes).to(torch.bfloat16))(y_f, (1, L), axes=(1, 2))[:, 0, :S, :]
        y = y + kv * ssm_D[None, None, :]
        return q * y

    def _B_ref(x, w_r, w_gate, w_up, w_down):
        B, S, D = x.shape
        C = 2
        r = x @ w_r
        idx = torch.argsort(-r, axis=-1)[:, :C]
        idx_e = (lambda x, n, axis: torch.repeat_interleave(x, n, dim=axis))(idx.reshape(B, C, 1), D, axis=2)
        x_sel = (lambda x, i, axis: torch.take_along_dim(x, i, dim=axis))(x, idx_e, axis=1)
        g = _silu(x_sel @ w_gate)
        u = x_sel @ w_up
        y = (g * u) @ w_down
        r_sel = _sigmoid((lambda x, i, axis: torch.take_along_dim(x, i, dim=axis))(r, idx, axis=1))
        y = y * r_sel.reshape(B, C, 1)
        b_off = (torch.arange(B) * S).reshape(B, 1)
        flat_idx = (idx + b_off).reshape(B * C)
        zero = (x * 0.0).reshape(B * S, D)
        upd = _scatter_add(zero, flat_idx, y.reshape(B * C, D), axis=0)
        return x + upd.reshape(B, S, D)

    x = A_q
    h = x + _A_ref(_layernorm(x, axis=-1), A_k, A_v, A_shift_k, A_ssm_k, A_ssm_D)
    h2 = h + _B_ref(_layernorm(h, axis=-1), B_w_r, B_w_gate, B_w_up, B_w_down)
    return h2
```

```asm
; @launch grid=(256,1,1) block=(256,1,1) lds=133632
.amdgcn_target "amdgcn-amd-amdhsa--gfx950"
.text
.globl sequential_preLN__ssm_conv_h3__moe_arch_mod__prompt_kernel
.p2align 8
.type sequential_preLN__ssm_conv_h3__moe_arch_mod__prompt_kernel,@function
sequential_preLN__ssm_conv_h3__moe_arch_mod__prompt_kernel:
    s_load_dwordx2 s[14:15], s[0:1], 24
    s_load_dwordx2 s[36:37], s[0:1], 8
    s_load_dwordx2 s[40:41], s[0:1], 16
    s_load_dwordx2 s[44:45], s[0:1], 104
    s_cmp_ge_u32 s2, 256
    s_cbranch_scc1 L_end
    s_mov_b32 s91, 0x00020000
    s_cmp_lt_u32 s2, 240
    s_cbranch_scc1 L_nocpf
    s_getpc_b64 s[88:89]
L_pc:
    s_mov_b32 s90, L_code_end-L_pc
    v_lshlrev_b32 v2, 7, v0
    buffer_load_dword v105, v2, s[88:91], 0 offen
L_nocpf:
    s_mul_i32 s69, s2, 6554
    s_lshr_b32 s69, s69, 16
    s_mul_i32 s70, s69, 10
    s_sub_u32 s86, s2, s70
    s_lshl_b32 s70, s69, 1
    s_sub_i32 s70, s70, 16
    s_max_i32 s87, s69, s70
    v_and_b32 v4, 7, v0
    v_lshrrev_b32 v5, 3, v0
    s_lshl_b32 s70, s86, 9
    v_lshl_add_u32 v12, v4, 6, s70
    s_mul_i32 s7, s87, 81920
    s_lshl_b32 s70, s86, 7
    s_add_u32 s7, s7, s70
    v_mul_u32_u24 v6, 2560, v5
    v_lshl_add_u32 v2, v4, 4, s7
    v_add_u32 v6, v2, v6
    s_mov_b32 s38, 2621440
    s_mov_b32 s39, s91
    s_mov_b32 s42, s38
    s_mov_b32 s43, s91
    v_subrev_u32 v7, 2560, v6
    v_subrev_u32 v8, 3840, v6
    v_lshlrev_b32 v14, 12, v5
    v_lshl_add_u32 v14, v4, 4, v14
    s_lshl_b32 s72, s86, 18
    s_lshl_b32 s7, s87, 7
    s_add_u32 s72, s72, s7
    s_cmp_lt_u32 s2, 240
    s_cselect_b32 s72, s72, 8388608
    s_mov_b32 s46, 8388608
    s_mov_b32 s47, s91
    s_mov_b32 s69, 6881280
    v_mov_b32 v252, -1
    v_mov_b32 v253, -1
    v_mov_b32 v254, -1
    v_mov_b32 v255, -1
    s_waitcnt lgkmcnt(0)
    s_load_dword s92, s[44:45], s69
    s_add_u32 s7, s72, 0
    buffer_store_dwordx4 v[252:255], v14, s[44:47], s7 offen sc1
    s_add_u32 s7, s72, 131072
    buffer_store_dwordx4 v[252:255], v14, s[44:47], s7 offen sc1
    s_cmp_lt_u32 s2, 160
    s_cbranch_scc1 L_no_p1
    s_add_u32 s7, s72, 128
    buffer_store_dwordx4 v[252:255], v14, s[44:47], s7 offen sc1
    s_add_u32 s7, s72, 131200
    buffer_store_dwordx4 v[252:255], v14, s[44:47], s7 offen sc1
L_no_p1:
    global_load_dwordx4 v[204:207], v12, s[14:15] offset:0
    global_load_dwordx4 v[208:211], v12, s[14:15] offset:16
    global_load_dwordx4 v[212:215], v12, s[14:15] offset:32
    global_load_dwordx4 v[216:219], v12, s[14:15] offset:48
    buffer_load_dwordx4 v[168:171], v6, s[40:43], 0 offen
    buffer_load_dwordx4 v[172:175], v6, s[40:43], 0 offen offset:1280
    buffer_load_dwordx4 v[160:163], v6, s[36:39], 0 offen
    buffer_load_dwordx4 v[164:167], v6, s[36:39], 0 offen offset:1280
    buffer_load_dwordx4 v[148:151], v8, s[36:39], 0 offen
    buffer_load_dwordx4 v[152:155], v7, s[36:39], 0 offen
    buffer_load_dwordx4 v[156:159], v7, s[36:39], 0 offen offset:1280
    s_load_dwordx2 s[8:9], s[0:1], 0
    s_load_dwordx8 s[16:23], s[0:1], 32
    s_load_dwordx8 s[24:31], s[0:1], 64
    s_load_dwordx4 s[32:35], s[0:1], 96
    s_cmp_lt_u32 s2, 160
    s_cbranch_scc1 L_no_t1
    s_mov_b32 s71, 81920
L_no_t1:
    v_and_b32 v1, 63, v0
    v_lshrrev_b32 v2, 6, v0
    s_mov_b32 s6, 0xffff0000
    v_readfirstlane_b32 s3, v2
    s_and_b32 s4, s2, 7
    s_lshr_b32 s5, s2, 3
    s_sub_u32 s85, s5, 20
    s_add_u32 s7, s5, 12
    s_and_b32 s7, s7, 31
    s_lshr_b32 s75, s7, 1
    s_lshl_b32 s75, s75, 3
    s_add_u32 s75, s75, s4
    s_and_b32 s7, s7, 1
    s_lshl_b32 s64, s75, 1
    s_add_u32 s64, s64, s7
    s_mul_i32 s74, s4, 6
    s_add_u32 s74, s74, s85
    s_mov_b32 s7, 6881280
    s_waitcnt lgkmcnt(0)
    s_add_u32 s92, s92, 1
    s_mov_b32 s56, s26
    s_mov_b32 s57, s27
    s_mov_b32 s58, 1966080
    s_mov_b32 s59, 0x00020000
    s_mov_b32 s88, s28
    s_mov_b32 s89, s29
    s_mov_b32 s90, 1966080
    s_mov_b32 s91, 0x00020000
    s_cmp_lt_u32 s2, 160
    s_cbranch_scc0 L_nc_start
    s_lshl_b32 s65, s2, 2
    s_add_u32 s65, s65, s3
    s_lshl_b32 s7, s65, 12
    s_add_u32 s48, s16, s7
    s_addc_u32 s49, s17, 0
    s_mov_b32 s50, 4096
    s_mov_b32 s51, 0x00020000
    s_lshr_b32 s7, s65, 1
    s_lshl_b32 s7, s7, 2
    s_load_dword s66, s[18:19], s7
    s_waitcnt vmcnt(11)
    s_barrier
    s_lshl_b32 s7, s2, 7
    s_add_u32 s7, s7, 6750208
    s_cmp_eq_u32 s3, 0
    s_cselect_b32 s7, s7, 8388608
    v_mov_b32 v2, s92
    s_mov_b64 exec, 1
    buffer_store_dword v2, off, s[44:47], s7 sc1
    s_mov_b64 exec, -1
    s_mul_i32 s70, s64, 2560
    s_add_u32 s70, s70, 5308416
    v_mov_b32 v13, s70
    s_lshl_b32 s7, s64, 7
    s_lshl_b32 s69, s64, 7
    s_add_u32 s69, s69, 5259264 - 2560
    v_mov_b32 v2, s69
    v_cmp_eq_u32 vcc, 20, v5
    s_nop 1
    v_cndmask_b32 v13, v13, v2, vcc
    s_add_u32 s69, s7, 6684672 - 2688
    v_mov_b32 v2, s69
    v_cmp_eq_u32 vcc, 21, v5
    s_nop 1
    v_cndmask_b32 v13, v13, v2, vcc
    s_lshl_b32 s7, s74, 7
    s_add_u32 s69, s7, 6619136 - 2816
    s_cmp_lt_u32 s85, 6
    s_cselect_b32 s69, s69, 8388608
    v_mov_b32 v2, s69
    v_cmp_eq_u32 vcc, 22, v5
    s_nop 1
    v_cndmask_b32 v13, v13, v2, vcc
    v_mov_b32 v2, 8388608
    v_cmp_lt_u32 vcc, 22, v5
    s_nop 1
    v_cndmask_b32 v13, v13, v2, vcc
    v_lshl_add_u32 v13, v0, 4, v13
    buffer_store_dwordx4 v[252:255], v13, s[44:47], 0 offen sc1
    v_lshlrev_b32 v2, 4, v1
    v_subrev_u32 v9, 64, v2
    v_subrev_u32 v10, 48, v2
    v_add_u32 v11, 960, v2
    buffer_load_dwordx4 v[76:79], v9, s[48:51], 0 offen
    buffer_load_dwordx2 v[80:81], v10, s[48:51], 0 offen
    buffer_load_dwordx4 v[82:85], v11, s[48:51], 0 offen offset:0
    buffer_load_dwordx2 v[86:87], v11, s[48:51], 0 offen offset:16
    buffer_load_dwordx4 v[88:91], v11, s[48:51], 0 offen offset:1024
    buffer_load_dwordx2 v[92:93], v11, s[48:51], 0 offen offset:1040
    buffer_load_dwordx4 v[94:97], v11, s[48:51], 0 offen offset:2048
    buffer_load_dwordx2 v[98:99], v11, s[48:51], 0 offen offset:2064
    buffer_load_dwordx4 v[100:103], v11, s[48:51], 0 offen offset:3072
    buffer_load_dwordx2 v[104:105], v11, s[48:51], 0 offen offset:3088
    s_mov_b32 s60, s8
    s_mov_b32 s61, s9
    s_mov_b32 s62, 2621440
    s_mov_b32 s63, 0x00020000
    s_mov_b32 s52, s30
    s_mov_b32 s53, s31
    s_mov_b32 s54, 2621440
    s_mov_b32 s55, 0x00020000
    s_lshl_b32 s69, s64, 2
    s_add_u32 s69, s69, s3
    s_mul_i32 s69, s69, 2560
    v_lshl_add_u32 v27, v1, 4, s69
    s_add_u32 s69, s69, 1024
    v_lshl_add_u32 v13, v1, 2, s69
    s_waitcnt vmcnt(19)
    v_and_b32 v220, 0xffff, v204
    v_lshrrev_b32 v221, 16, v204
    v_and_b32 v222, 0xffff, v205
    v_lshrrev_b32 v223, 16, v205
    v_lshlrev_b32 v224, 16, v206
    v_and_b32 v225, s6, v206
    v_lshlrev_b32 v226, 16, v207
    v_and_b32 v227, s6, v207
    v_and_b32 v228, 0xffff, v208
    v_lshrrev_b32 v229, 16, v208
    v_and_b32 v230, 0xffff, v209
    v_lshrrev_b32 v231, 16, v209
    v_lshlrev_b32 v232, 16, v210
    v_and_b32 v233, s6, v210
    v_lshlrev_b32 v234, 16, v211
    v_and_b32 v235, s6, v211
    v_and_b32 v236, 0xffff, v212
    v_lshrrev_b32 v237, 16, v212
    v_and_b32 v238, 0xffff, v213
    v_lshrrev_b32 v239, 16, v213
    v_lshlrev_b32 v240, 16, v214
    v_and_b32 v241, s6, v214
    v_lshlrev_b32 v242, 16, v215
    v_and_b32 v243, s6, v215
    v_and_b32 v244, 0xffff, v216
    v_lshrrev_b32 v245, 16, v216
    v_and_b32 v246, 0xffff, v217
    v_lshrrev_b32 v247, 16, v217
    v_lshlrev_b32 v248, 16, v218
    v_and_b32 v249, s6, v218
    v_lshlrev_b32 v250, 16, v219
    v_and_b32 v251, s6, v219
    v_xor_b32 v2, 3, v5
    v_lshrrev_b32 v3, 2, v5
    v_xor_b32 v3, v3, v4
    v_and_b32 v2, 3, v2
    v_lshlrev_b32 v2, 2, v2
    v_lshl_add_u32 v2, v3, 4, v2
    v_add_u32 v2, 87552, v2
    v_lshl_add_u32 v6, v4, 10, v2
    v_xor_b32 v3, s3, v4
    v_lshlrev_b32 v2, 7, v5
    v_add_u32 v2, 87552, v2
    v_lshl_add_u32 v7, v3, 4, v2
    v_xor_b32 v3, 4, v3
    v_lshl_add_u32 v8, v3, 4, v2
    s_waitcnt vmcnt(12)
    v_dot2_f32_bf16 v32, v160, v220, 0
    v_dot2_f32_bf16 v33, v164, v220, 0
    v_dot2_f32_bf16 v34, v160, v224, 0
    v_dot2_f32_bf16 v35, v164, v224, 0
    v_dot2_f32_bf16 v36, v161, v228, 0
    v_dot2_f32_bf16 v37, v165, v228, 0
    v_dot2_f32_bf16 v38, v161, v232, 0
    v_dot2_f32_bf16 v39, v165, v232, 0
    v_dot2c_f32_bf16 v32, v156, v221
    v_dot2c_f32_bf16 v33, v160, v221
    v_dot2c_f32_bf16 v34, v156, v225
    v_dot2c_f32_bf16 v35, v160, v225
    v_dot2c_f32_bf16 v36, v157, v229
    v_dot2c_f32_bf16 v37, v161, v229
    v_dot2c_f32_bf16 v38, v157, v233
    v_dot2c_f32_bf16 v39, v161, v233
    v_dot2c_f32_bf16 v32, v152, v222
    v_dot2c_f32_bf16 v33, v156, v222
    v_dot2c_f32_bf16 v34, v152, v226
    v_dot2c_f32_bf16 v35, v156, v226
    v_dot2c_f32_bf16 v36, v153, v230
    v_dot2c_f32_bf16 v37, v157, v230
    v_dot2c_f32_bf16 v38, v153, v234
    v_dot2c_f32_bf16 v39, v157, v234
    v_dot2c_f32_bf16 v32, v148, v223
    v_dot2c_f32_bf16 v33, v152, v223
    v_dot2c_f32_bf16 v34, v148, v227
    v_dot2c_f32_bf16 v35, v152, v227
    v_dot2c_f32_bf16 v36, v149, v231
    v_dot2c_f32_bf16 v37, v153, v231
    v_dot2c_f32_bf16 v38, v149, v235
    v_dot2c_f32_bf16 v39, v153, v235
    v_lshlrev_b32 v52, 16, v168
    v_lshlrev_b32 v53, 16, v172
    v_and_b32 v54, s6, v168
    v_and_b32 v55, s6, v172
    v_lshlrev_b32 v56, 16, v169
    v_lshlrev_b32 v57, 16, v173
    v_and_b32 v58, s6, v169
    v_and_b32 v59, s6, v173
    v_mul_f32 v32, v32, v52
    v_mul_f32 v33, v33, v53
    v_mul_f32 v34, v34, v54
    v_mul_f32 v35, v35, v55
    v_mul_f32 v36, v36, v56
    v_mul_f32 v37, v37, v57
    v_mul_f32 v38, v38, v58
    v_mul_f32 v39, v39, v59
    v_cvt_pk_bf16_f32 v32, v33, v32
    ds_write_b32 v6, v32 offset:0
    v_cvt_pk_bf16_f32 v34, v35, v34
    ds_write_b32 v6, v34 offset:128
    v_cvt_pk_bf16_f32 v36, v37, v36
    ds_write_b32 v6, v36 offset:256
    v_cvt_pk_bf16_f32 v38, v39, v38
    ds_write_b32 v6, v38 offset:384
    v_dot2_f32_bf16 v40, v162, v236, 0
    v_dot2_f32_bf16 v41, v166, v236, 0
    v_dot2_f32_bf16 v42, v162, v240, 0
    v_dot2_f32_bf16 v43, v166, v240, 0
    v_dot2_f32_bf16 v44, v163, v244, 0
    v_dot2_f32_bf16 v45, v167, v244, 0
    v_dot2_f32_bf16 v46, v163, v248, 0
    v_dot2_f32_bf16 v47, v167, v248, 0
    v_dot2c_f32_bf16 v40, v158, v237
    v_dot2c_f32_bf16 v41, v162, v237
    v_dot2c_f32_bf16 v42, v158, v241
    v_dot2c_f32_bf16 v43, v162, v241
    v_dot2c_f32_bf16 v44, v159, v245
    v_dot2c_f32_bf16 v45, v163, v245
    v_dot2c_f32_bf16 v46, v159, v249
    v_dot2c_f32_bf16 v47, v163, v249
    v_dot2c_f32_bf16 v40, v154, v238
    v_dot2c_f32_bf16 v41, v158, v238
    v_dot2c_f32_bf16 v42, v154, v242
    v_dot2c_f32_bf16 v43, v158, v242
    v_dot2c_f32_bf16 v44, v155, v246
    v_dot2c_f32_bf16 v45, v159, v246
    v_dot2c_f32_bf16 v46, v155, v250
    v_dot2c_f32_bf16 v47, v159, v250
    v_dot2c_f32_bf16 v40, v150, v239
    v_dot2c_f32_bf16 v41, v154, v239
    v_dot2c_f32_bf16 v42, v150, v243
    v_dot2c_f32_bf16 v43, v154, v243
    v_dot2c_f32_bf16 v44, v151, v247
    v_dot2c_f32_bf16 v45, v155, v247
    v_dot2c_f32_bf16 v46, v151, v251
    v_dot2c_f32_bf16 v47, v155, v251
    v_lshlrev_b32 v52, 16, v170
    v_lshlrev_b32 v53, 16, v174
    v_and_b32 v54, s6, v170
    v_and_b32 v55, s6, v174
    v_lshlrev_b32 v56, 16, v171
    v_lshlrev_b32 v57, 16, v175
    v_and_b32 v58, s6, v171
    v_and_b32 v59, s6, v175
    v_mul_f32 v40, v40, v52
    v_mul_f32 v41, v41, v53
    v_mul_f32 v42, v42, v54
    v_mul_f32 v43, v43, v55
    v_mul_f32 v44, v44, v56
    v_mul_f32 v45, v45, v57
    v_mul_f32 v46, v46, v58
    v_mul_f32 v47, v47, v59
    v_cvt_pk_bf16_f32 v40, v41, v40
    ds_write_b32 v6, v40 offset:512
    v_cvt_pk_bf16_f32 v42, v43, v42
    ds_write_b32 v6, v42 offset:640
    v_cvt_pk_bf16_f32 v44, v45, v44
    ds_write_b32 v6, v44 offset:768
    v_cvt_pk_bf16_f32 v46, v47, v46
    ds_write_b32 v6, v46 offset:896
    s_waitcnt lgkmcnt(0)
    s_barrier
    ds_read_b128 v[60:63], v7 offset:0
    ds_read_b128 v[64:67], v8 offset:4096
    s_waitcnt lgkmcnt(0)
    s_add_u32 s7, s72, 0
    buffer_store_dwordx4 v[60:63], v14, s[44:47], s7 offen sc1
    s_add_u32 s7, s72, 131072
    buffer_store_dwordx4 v[64:67], v14, s[44:47], s7 offen sc1
    s_mul_i32 s7, s3, 16640
    v_lshl_add_u32 v4, v1, 4, s7
    s_waitcnt vmcnt(2)
    v_alignbit_b32 v112, v77, v76, 16
    v_alignbit_b32 v113, v78, v77, 16
    v_alignbit_b32 v114, v79, v78, 16
    v_alignbit_b32 v115, v80, v79, 16
    ds_write_b128 v4, v[112:115] offset:0
    v_pk_mov_b32 v[116:117], v[76:77], v[78:79] op_sel:[1,0]
    v_pk_mov_b32 v[118:119], v[78:79], v[80:81] op_sel:[1,0]
    ds_write_b128 v4, v[116:119] offset:4160
    v_alignbit_b32 v120, v78, v77, 16
    v_alignbit_b32 v121, v79, v78, 16
    v_alignbit_b32 v122, v80, v79, 16
    v_alignbit_b32 v123, v81, v80, 16
    ds_write_b128 v4, v[120:123] offset:8320
    ds_write_b128 v4, v[78:81] offset:12480
    s_lshr_b32 s10, s2, 4
    s_lshl_b32 s10, s10, 7
    s_add_u32 s10, s10, 6750208
    v_min_u32 v12, 23, v1
    v_mul_u32_u24 v12, 1280, v12
    v_and_b32 v222, 7, v1
    v_mul_u32_u24 v222, 1280, v222
    v_add_u32 v222, 20480, v222
    buffer_load_dword v110, v12, s[44:47], s10 offen sc1
    s_lshl_b32 s11, s65, 12
    v_lshlrev_b32 v14, 4, v1
    v_alignbit_b32 v124, v83, v82, 16
    v_alignbit_b32 v125, v84, v83, 16
    v_alignbit_b32 v126, v85, v84, 16
    v_alignbit_b32 v127, v86, v85, 16
    ds_write_b128 v4, v[124:127] offset:1024
    v_pk_mov_b32 v[128:129], v[82:83], v[84:85] op_sel:[1,0]
    v_pk_mov_b32 v[130:131], v[84:85], v[86:87] op_sel:[1,0]
    ds_write_b128 v4, v[128:131] offset:5184
    v_alignbit_b32 v132, v84, v83, 16
    v_alignbit_b32 v133, v85, v84, 16
    v_alignbit_b32 v134, v86, v85, 16
    v_alignbit_b32 v135, v87, v86, 16
    ds_write_b128 v4, v[132:135] offset:9344
    ds_write_b128 v4, v[84:87] offset:13504
    v_alignbit_b32 v112, v89, v88, 16
    v_alignbit_b32 v113, v90, v89, 16
    v_alignbit_b32 v114, v91, v90, 16
    v_alignbit_b32 v115, v92, v91, 16
    ds_write_b128 v4, v[112:115] offset:2048
    v_pk_mov_b32 v[116:117], v[88:89], v[90:91] op_sel:[1,0]
    v_pk_mov_b32 v[118:119], v[90:91], v[92:93] op_sel:[1,0]
    ds_write_b128 v4, v[116:119] offset:6208
    v_alignbit_b32 v120, v90, v89, 16
    v_alignbit_b32 v121, v91, v90, 16
    v_alignbit_b32 v122, v92, v91, 16
    v_alignbit_b32 v123, v93, v92, 16
    ds_write_b128 v4, v[120:123] offset:10368
    ds_write_b128 v4, v[90:93] offset:14528
    v_alignbit_b32 v124, v95, v94, 16
    v_alignbit_b32 v125, v96, v95, 16
    v_alignbit_b32 v126, v97, v96, 16
    v_alignbit_b32 v127, v98, v97, 16
    ds_write_b128 v4, v[124:127] offset:3072
    v_pk_mov_b32 v[128:129], v[94:95], v[96:97] op_sel:[1,0]
    v_pk_mov_b32 v[130:131], v[96:97], v[98:99] op_sel:[1,0]
    ds_write_b128 v4, v[128:131] offset:7232
    v_alignbit_b32 v132, v96, v95, 16
    v_alignbit_b32 v133, v97, v96, 16
    v_alignbit_b32 v134, v98, v97, 16
    v_alignbit_b32 v135, v99, v98, 16
    ds_write_b128 v4, v[132:135] offset:11392
    ds_write_b128 v4, v[96:99] offset:15552
    s_mov_b64 exec, 15
    v_alignbit_b32 v112, v101, v100, 16
    v_alignbit_b32 v113, v102, v101, 16
    v_alignbit_b32 v114, v103, v102, 16
    v_alignbit_b32 v115, v104, v103, 16
    ds_write_b128 v4, v[112:115] offset:4096
    v_pk_mov_b32 v[116:117], v[100:101], v[102:103] op_sel:[1,0]
    v_pk_mov_b32 v[118:119], v[102:103], v[104:105] op_sel:[1,0]
    ds_write_b128 v4, v[116:119] offset:8256
    v_alignbit_b32 v120, v102, v101, 16
    v_alignbit_b32 v121, v103, v102, 16
    v_alignbit_b32 v122, v104, v103, 16
    v_alignbit_b32 v123, v105, v104, 16
    ds_write_b128 v4, v[120:123] offset:12416
    ds_write_b128 v4, v[102:105] offset:16576
    s_mov_b64 exec, -1
    v_and_b32 v2, 3, v1
    v_mul_u32_u24 v5, 4160, v2
    v_lshrrev_b32 v3, 2, v1
    v_lshl_add_u32 v5, v3, 3, v5
    s_add_u32 s7, s7, 32
    v_add_u32 v5, s7, v5
    s_mul_i32 s69, s3, 4736
    s_add_u32 s69, s69, 66560
    v_and_b32 v2, 1, v1
    v_mul_u32_u24 v6, 2368, v2
    v_lshrrev_b32 v3, 1, v1
    v_lshl_add_u32 v6, v3, 4, v6
    v_add_u32 v6, s69, v6
    v_mov_b32 v112, 0
    v_mov_b32 v113, 0
    v_mov_b32 v114, 0
    v_mov_b32 v115, 0
    s_mov_b32 exec_hi, 0
    ds_write_b128 v6, v[112:115]
    s_mov_b32 exec_hi, -1
    v_and_b32 v2, 15, v1
    v_lshrrev_b32 v3, 4, v1
    v_sub_u32 v7, v2, v3
    v_lshl_add_u32 v7, v7, 4, s69
    v_add_u32 v7, 64, v7
    v_lshrrev_b32 v9, 5, v1
    v_mul_u32_u24 v8, 2368, v9
    v_lshl_add_u32 v8, v2, 4, v8
    v_add_u32 v8, s69, v8
    v_and_b32 v3, 1, v3
    v_lshlrev_b32 v10, 3, v3
    v_sub_u32 v8, v8, v10
    v_add_u32 v8, 8, v8
    v_lshl_add_u32 v9, v9, 6, v10
    v_and_b32 v3, 1, v2
    v_lshl_add_u32 v9, v3, 7, v9
    v_lshrrev_b32 v3, 1, v2
    v_mul_u32_u24 v3, 272, v3
    s_lshl_b32 s7, s3, 4
    s_add_u32 s7, s7, 103936
    v_add3_u32 v9, v9, v3, s7
    v_lshrrev_b32 v2, 4, v0
    v_mul_u32_u24 v10, 272, v2
    v_and_b32 v3, 15, v0
    v_lshl_add_u32 v10, v3, 4, v10
    v_add_u32 v10, 103936, v10
    v_lshrrev_b32 v2, 3, v0
    v_mul_u32_u24 v11, 20480, v2
    v_and_b32 v3, 7, v0
    v_lshl_add_u32 v11, v3, 4, v11
    s_lshl_b32 s73, s2, 7
    s_add_u32 s73, s73, 2621440
    s_waitcnt lgkmcnt(0)
    s_bitcmp1_b32 s65, 0
    s_cselect_b32 s7, 16, 0
    s_lshr_b32 s66, s66, s7
    s_and_b32 s66, s66, 0xffff
    s_lshl_b32 s67, s66, 16
    ds_read_b64 a[248:249], v5 offset:3968
    ds_read_b64 a[250:251], v5 offset:3976
    ds_read_b64 a[252:253], v5 offset:3984
    ds_read_b64 a[254:255], v5 offset:3992
    ds_read_b64 a[216:217], v5 offset:3456
    ds_read_b64 a[218:219], v5 offset:3464
    ds_read_b64 a[220:221], v5 offset:3472
    ds_read_b64 a[222:223], v5 offset:3480
    ds_read_b64 a[184:185], v5 offset:2944
    ds_read_b64 a[186:187], v5 offset:2952
    ds_read_b64 a[188:189], v5 offset:2960
    ds_read_b64 a[190:191], v5 offset:2968
    ds_read_b64 a[152:153], v5 offset:2432
    ds_read_b64 a[154:155], v5 offset:2440
    ds_read_b64 a[156:157], v5 offset:2448
    ds_read_b64 a[158:159], v5 offset:2456
    ds_read_b64 a[120:121], v5 offset:1920
    ds_read_b64 a[122:123], v5 offset:1928
    ds_read_b64 a[124:125], v5 offset:1936
    ds_read_b64 a[126:127], v5 offset:1944
    ds_read_b64 a[88:89], v5 offset:1408
    ds_read_b64 a[90:91], v5 offset:1416
    ds_read_b64 a[92:93], v5 offset:1424
    ds_read_b64 a[94:95], v5 offset:1432
    ds_read_b64 a[56:57], v5 offset:896
    ds_read_b64 a[58:59], v5 offset:904
    ds_read_b64 a[60:61], v5 offset:912
    ds_read_b64 a[62:63], v5 offset:920
    ds_read_b64 a[24:25], v5 offset:384
    ds_read_b64 a[26:27], v5 offset:392
    ds_read_b64 a[28:29], v5 offset:400
    ds_read_b64 a[30:31], v5 offset:408
    s_waitcnt vmcnt(0)
    v_cmp_ne_u32 vcc, s92, v110
    s_cbranch_vccnz L_f0a_slow
L_f0a_ok:
    buffer_load_dwordx4 v[164:167], v14, s[44:47], s11 offen offset:0 sc1
    buffer_load_dwordx4 v[168:171], v14, s[44:47], s11 offen offset:1024 sc1
    ds_read_b64 a[240:241], v5 offset:3840
    ds_read_b64 a[242:243], v5 offset:3848
    ds_read_b64 a[244:245], v5 offset:3856
    ds_read_b64 a[246:247], v5 offset:3864
    ds_read_b64 a[208:209], v5 offset:3328
    ds_read_b64 a[210:211], v5 offset:3336
    ds_read_b64 a[212:213], v5 offset:3344
    ds_read_b64 a[214:215], v5 offset:3352
    ds_read_b64 a[176:177], v5 offset:2816
    ds_read_b64 a[178:179], v5 offset:2824
    ds_read_b64 a[180:181], v5 offset:2832
    ds_read_b64 a[182:183], v5 offset:2840
    ds_read_b64 a[144:145], v5 offset:2304
    ds_read_b64 a[146:147], v5 offset:2312
    ds_read_b64 a[148:149], v5 offset:2320
    ds_read_b64 a[150:151], v5 offset:2328
    ds_read_b64 a[112:113], v5 offset:1792
    ds_read_b64 a[114:115], v5 offset:1800
    ds_read_b64 a[116:117], v5 offset:1808
    ds_read_b64 a[118:119], v5 offset:1816
    ds_read_b64 a[80:81], v5 offset:1280
    ds_read_b64 a[82:83], v5 offset:1288
    ds_read_b64 a[84:85], v5 offset:1296
    ds_read_b64 a[86:87], v5 offset:1304
    ds_read_b64 a[48:49], v5 offset:768
    ds_read_b64 a[50:51], v5 offset:776
    ds_read_b64 a[52:53], v5 offset:784
    ds_read_b64 a[54:55], v5 offset:792
    ds_read_b64 a[16:17], v5 offset:256
    ds_read_b64 a[18:19], v5 offset:264
    ds_read_b64 a[20:21], v5 offset:272
    ds_read_b64 a[22:23], v5 offset:280
    ds_read_b64 a[232:233], v5 offset:3712
    ds_read_b64 a[234:235], v5 offset:3720
    ds_read_b64 a[236:237], v5 offset:3728
    ds_read_b64 a[238:239], v5 offset:3736
    ds_read_b64 a[200:201], v5 offset:3200
    ds_read_b64 a[202:203], v5 offset:3208
    ds_read_b64 a[204:205], v5 offset:3216
    ds_read_b64 a[206:207], v5 offset:3224
    ds_read_b64 a[168:169], v5 offset:2688
    ds_read_b64 a[170:171], v5 offset:2696
    ds_read_b64 a[172:173], v5 offset:2704
    ds_read_b64 a[174:175], v5 offset:2712
    ds_read_b64 a[136:137], v5 offset:2176
    ds_read_b64 a[138:139], v5 offset:2184
    ds_read_b64 a[140:141], v5 offset:2192
    ds_read_b64 a[142:143], v5 offset:2200
    ds_read_b64 a[104:105], v5 offset:1664
    ds_read_b64 a[106:107], v5 offset:1672
    ds_read_b64 a[108:109], v5 offset:1680
    ds_read_b64 a[110:111], v5 offset:1688
    ds_read_b64 a[72:73], v5 offset:1152
    ds_read_b64 a[74:75], v5 offset:1160
    ds_read_b64 a[76:77], v5 offset:1168
    ds_read_b64 a[78:79], v5 offset:1176
    ds_read_b64 a[40:41], v5 offset:640
    ds_read_b64 a[42:43], v5 offset:648
    ds_read_b64 a[44:45], v5 offset:656
    ds_read_b64 a[46:47], v5 offset:664
    ds_read_b64 a[8:9], v5 offset:128
    ds_read_b64 a[10:11], v5 offset:136
    ds_read_b64 a[12:13], v5 offset:144
    ds_read_b64 a[14:15], v5 offset:152
    ds_read_b64 a[224:225], v5 offset:3584
    ds_read_b64 a[226:227], v5 offset:3592
    ds_read_b64 a[228:229], v5 offset:3600
    ds_read_b64 a[230:231], v5 offset:3608
    ds_read_b64 a[192:193], v5 offset:3072
    ds_read_b64 a[194:195], v5 offset:3080
    ds_read_b64 a[196:197], v5 offset:3088
    ds_read_b64 a[198:199], v5 offset:3096
    ds_read_b64 a[160:161], v5 offset:2560
    ds_read_b64 a[162:163], v5 offset:2568
    ds_read_b64 a[164:165], v5 offset:2576
    ds_read_b64 a[166:167], v5 offset:2584
    ds_read_b64 a[128:129], v5 offset:2048
    ds_read_b64 a[130:131], v5 offset:2056
    ds_read_b64 a[132:133], v5 offset:2064
    ds_read_b64 a[134:135], v5 offset:2072
    ds_read_b64 a[96:97], v5 offset:1536
    ds_read_b64 a[98:99], v5 offset:1544
    ds_read_b64 a[100:101], v5 offset:1552
    ds_read_b64 a[102:103], v5 offset:1560
    ds_read_b64 a[64:65], v5 offset:1024
    ds_read_b64 a[66:67], v5 offset:1032
    ds_read_b64 a[68:69], v5 offset:1040
    ds_read_b64 a[70:71], v5 offset:1048
    ds_read_b64 a[32:33], v5 offset:512
    ds_read_b64 a[34:35], v5 offset:520
    ds_read_b64 a[36:37], v5 offset:528
    ds_read_b64 a[38:39], v5 offset:536
    ds_read_b64 a[0:1], v5 offset:0
    ds_read_b64 a[2:3], v5 offset:8
    ds_read_b64 a[4:5], v5 offset:16
    ds_read_b64 a[6:7], v5 offset:24
    s_waitcnt vmcnt(0)
    v_max3_u32 v2, v164, v165, v166
    v_max3_u32 v2, v2, v167, v168
    v_max3_u32 v2, v2, v169, v170
    v_max_u32 v2, v2, v171
    v_cmp_eq_u32 vcc, -1, v2
    s_cbranch_vccnz L_ua_slow
L_ua_ok:
    ds_write_b128 v6, v[164:167] offset:256
    ds_read_b128 v[64:67], v7 offset:0
    ds_read_b128 v[68:71], v7 offset:2368
    ds_read_b128 v[72:75], v7 offset:64
    ds_read_b128 v[76:79], v7 offset:2432
    ds_write_b128 v6, v[168:171] offset:768
    s_waitcnt lgkmcnt(3)
    v_mfma_f32_16x16x32_bf16 v[60:63], a[252:255], v[64:67], 0
    ds_read_b128 v[80:83], v7 offset:128
    v_mfma_f32_16x16x32_bf16 v[56:59], a[220:223], v[64:67], 0
    ds_read_b128 v[84:87], v7 offset:2496
    v_mfma_f32_16x16x32_bf16 v[52:55], a[188:191], v[64:67], 0
    buffer_load_dwordx4 v[172:175], v14, s[44:47], s11 offen offset:2048 sc1
    v_mfma_f32_16x16x32_bf16 v[48:51], a[156:159], v[64:67], 0
    buffer_load_dwordx4 v[176:179], v14, s[44:47], s11 offen offset:3072 sc1
    v_mfma_f32_16x16x32_bf16 v[44:47], a[124:127], v[64:67], 0
    v_mfma_f32_16x16x32_bf16 v[40:43], a[92:95], v[64:67], 0
    v_mfma_f32_16x16x32_bf16 v[36:39], a[60:63], v[64:67], 0
    v_mfma_f32_16x16x32_bf16 v[32:35], a[28:31], v[64:67], 0
    v_mfma_f32_16x16x32_bf16 v[60:63], a[248:251], v[68:71], v[60:63]
    v_mfma_f32_16x16x32_bf16 v[56:59], a[216:219], v[68:71], v[56:59]
    v_mfma_f32_16x16x32_bf16 v[52:55], a[184:187], v[68:71], v[52:55]
    v_mfma_f32_16x16x32_bf16 v[48:51], a[152:155], v[68:71], v[48:51]
    v_mfma_f32_16x16x32_bf16 v[44:47], a[120:123], v[68:71], v[44:47]
    v_mfma_f32_16x16x32_bf16 v[40:43], a[88:91], v[68:71], v[40:43]
    v_mfma_f32_16x16x32_bf16 v[36:39], a[56:59], v[68:71], v[36:39]
    v_mfma_f32_16x16x32_bf16 v[32:35], a[24:27], v[68:71], v[32:35]
    s_waitcnt lgkmcnt(3)
    v_mfma_f32_16x16x32_bf16 v[60:63], a[244:247], v[72:75], v[60:63]
    ds_read_b128 v[88:91], v7 offset:192
    v_mfma_f32_16x16x32_bf16 v[56:59], a[212:215], v[72:75], v[56:59]
    ds_read_b128 v[92:95], v7 offset:2560
    v_mfma_f32_16x16x32_bf16 v[52:55], a[180:183], v[72:75], v[52:55]
    s_add_u32 s7, s73, 0
    buffer_store_dwordx4 v[252:255], v11, s[44:47], s7 offen sc1
    v_mfma_f32_16x16x32_bf16 v[48:51], a[148:151], v[72:75], v[48:51]
    v_mfma_f32_16x16x32_bf16 v[44:47], a[116:119], v[72:75], v[44:47]
    s_add_u32 s7, s73, 655360
    buffer_store_dwordx4 v[252:255], v11, s[44:47], s7 offen sc1
    v_mfma_f32_16x16x32_bf16 v[40:43], a[84:87], v[72:75], v[40:43]
    v_mfma_f32_16x16x32_bf16 v[36:39], a[52:55], v[72:75], v[36:39]
    s_add_u32 s7, s73, 1310720
    buffer_store_dwordx4 v[252:255], v11, s[44:47], s7 offen sc1
    v_mfma_f32_16x16x32_bf16 v[32:35], a[20:23], v[72:75], v[32:35]
    v_mfma_f32_16x16x32_bf16 v[60:63], a[240:243], v[76:79], v[60:63]
    s_add_u32 s7, s73, 1966080
    buffer_store_dwordx4 v[252:255], v11, s[44:47], s7 offen sc1
    v_mfma_f32_16x16x32_bf16 v[56:59], a[208:211], v[76:79], v[56:59]
    v_mfma_f32_16x16x32_bf16 v[52:55], a[176:179], v[76:79], v[52:55]
    v_mfma_f32_16x16x32_bf16 v[48:51], a[144:147], v[76:79], v[48:51]
    v_mfma_f32_16x16x32_bf16 v[44:47], a[112:115], v[76:79], v[44:47]
    v_mfma_f32_16x16x32_bf16 v[40:43], a[80:83], v[76:79], v[40:43]
    v_mfma_f32_16x16x32_bf16 v[36:39], a[48:51], v[76:79], v[36:39]
    v_mfma_f32_16x16x32_bf16 v[32:35], a[16:19], v[76:79], v[32:35]
    s_waitcnt lgkmcnt(2)
    v_mfma_f32_16x16x32_bf16 v[60:63], a[236:239], v[80:83], v[60:63]
    ds_read_b128 v[96:99], v7 offset:256
    ds_read_b64 v[112:113], v8 offset:256
    v_mfma_f32_16x16x32_bf16 v[56:59], a[204:207], v[80:83], v[56:59]
    ds_read_b128 v[100:103], v7 offset:2624
    v_mfma_f32_16x16x32_bf16 v[52:55], a[172:175], v[80:83], v[52:55]
    v_mfma_f32_16x16x32_bf16 v[48:51], a[140:143], v[80:83], v[48:51]
    v_mfma_f32_16x16x32_bf16 v[44:47], a[108:111], v[80:83], v[44:47]
    v_mfma_f32_16x16x32_bf16 v[40:43], a[76:79], v[80:83], v[40:43]
    v_mfma_f32_16x16x32_bf16 v[36:39], a[44:47], v[80:83], v[36:39]
    s_waitcnt lgkmcnt(1)
    v_and_b32 v128, s6, v113
    v_lshlrev_b32 v129, 16, v113
    v_mfma_f32_16x16x32_bf16 v[32:35], a[12:15], v[80:83], v[32:35]
    v_and_b32 v130, s6, v112
    v_lshlrev_b32 v131, 16, v112
    v_mfma_f32_16x16x32_bf16 v[60:63], a[232:235], v[84:87], v[60:63]
    v_mfma_f32_16x16x32_bf16 v[56:59], a[200:203], v[84:87], v[56:59]
    v_mfma_f32_16x16x32_bf16 v[52:55], a[168:171], v[84:87], v[52:55]
    v_mfma_f32_16x16x32_bf16 v[48:51], a[136:139], v[84:87], v[48:51]
    v_mfma_f32_16x16x32_bf16 v[44:47], a[104:107], v[84:87], v[44:47]
    v_mfma_f32_16x16x32_bf16 v[40:43], a[72:75], v[84:87], v[40:43]
    v_mfma_f32_16x16x32_bf16 v[36:39], a[40:43], v[84:87], v[36:39]
    v_mfma_f32_16x16x32_bf16 v[32:35], a[8:11], v[84:87], v[32:35]
    s_waitcnt lgkmcnt(3)
    v_mfma_f32_16x16x32_bf16 v[60:63], a[228:231], v[88:91], v[60:63]
    ds_read_b128 v[104:107], v7 offset:320
    v_mfma_f32_16x16x32_bf16 v[56:59], a[196:199], v[88:91], v[56:59]
    ds_read_b128 v[108:111], v7 offset:2688
    v_mfma_f32_16x16x32_bf16 v[52:55], a[164:167], v[88:91], v[52:55]
    v_mfma_f32_16x16x32_bf16 v[48:51], a[132:135], v[88:91], v[48:51]
    v_mfma_f32_16x16x32_bf16 v[44:47], a[100:103], v[88:91], v[44:47]
    v_mfma_f32_16x16x32_bf16 v[40:43], a[68:71], v[88:91], v[40:43]
    v_mfma_f32_16x16x32_bf16 v[36:39], a[36:39], v[88:91], v[36:39]
    v_mfma_f32_16x16x32_bf16 v[32:35], a[4:7], v[88:91], v[32:35]
    v_mfma_f32_16x16x32_bf16 v[60:63], a[224:227], v[92:95], v[60:63]
    v_mfma_f32_16x16x32_bf16 v[56:59], a[192:195], v[92:95], v[56:59]
    v_mfma_f32_16x16x32_bf16 v[52:55], a[160:163], v[92:95], v[52:55]
    v_mfma_f32_16x16x32_bf16 v[48:51], a[128:131], v[92:95], v[48:51]
    v_mfma_f32_16x16x32_bf16 v[44:47], a[96:99], v[92:95], v[44:47]
    v_mfma_f32_16x16x32_bf16 v[40:43], a[64:67], v[92:95], v[40:43]
    v_mfma_f32_16x16x32_bf16 v[36:39], a[32:35], v[92:95], v[36:39]
    v_mfma_f32_16x16x32_bf16 v[32:35], a[0:3], v[92:95], v[32:35]
    s_waitcnt lgkmcnt(2)
    v_mfma_f32_16x16x32_bf16 v[60:63], a[220:223], v[96:99], v[60:63]
    ds_read_b128 v[64:67], v7 offset:384
    v_mfma_f32_16x16x32_bf16 v[56:59], a[188:191], v[96:99], v[56:59]
    ds_read_b128 v[68:71], v7 offset:2752
    v_mfma_f32_16x16x32_bf16 v[52:55], a[156:159], v[96:99], v[52:55]
    v_mfma_f32_16x16x32_bf16 v[48:51], a[124:127], v[96:99], v[48:51]
    s_nop 0
    v_fmac_f32 v32, s67, v128
    v_fmac_f32 v33, s67, v129
    v_mfma_f32_16x16x32_bf16 v[44:47], a[92:95], v[96:99], v[44:47]
    v_fmac_f32 v34, s67, v130
    v_fmac_f32 v35, s67, v131
    v_mfma_f32_16x16x32_bf16 v[40:43], a[60:63], v[96:99], v[40:43]
    v_cvt_pk_bf16_f32 v124, v32, v33
    v_cvt_pk_bf16_f32 v125, v34, v35
    v_mfma_f32_16x16x32_bf16 v[36:39], a[28:31], v[96:99], v[36:39]
    ds_write_b64 v9, v[124:125] offset:0
    v_mfma_f32_16x16x32_bf16 v[60:63], a[216:219], v[100:103], v[60:63]
    v_mfma_f32_16x16x32_bf16 v[56:59], a[184:187], v[100:103], v[56:59]
    v_mfma_f32_16x16x32_bf16 v[52:55], a[152:155], v[100:103], v[52:55]
    v_mfma_f32_16x16x32_bf16 v[48:51], a[120:123], v[100:103], v[48:51]
    v_mfma_f32_16x16x32_bf16 v[44:47], a[88:91], v[100:103], v[44:47]
    v_mfma_f32_16x16x32_bf16 v[40:43], a[56:59], v[100:103], v[40:43]
    v_mfma_f32_16x16x32_bf16 v[36:39], a[24:27], v[100:103], v[36:39]
    s_waitcnt lgkmcnt(3)
    v_mfma_f32_16x16x32_bf16 v[60:63], a[212:215], v[104:107], v[60:63]
    ds_read_b128 v[72:75], v7 offset:448
    ds_read_b64 v[114:115], v8 offset:512
    v_mfma_f32_16x16x32_bf16 v[56:59], a[180:183], v[104:107], v[56:59]
    ds_read_b128 v[76:79], v7 offset:2816
    v_mfma_f32_16x16x32_bf16 v[52:55], a[148:151], v[104:107], v[52:55]
    v_mfma_f32_16x16x32_bf16 v[48:51], a[116:119], v[104:107], v[48:51]
    v_mfma_f32_16x16x32_bf16 v[44:47], a[84:87], v[104:107], v[44:47]
    v_mfma_f32_16x16x32_bf16 v[40:43], a[52:55], v[104:107], v[40:43]
    v_mfma_f32_16x16x32_bf16 v[36:39], a[20:23], v[104:107], v[36:39]
    s_waitcnt lgkmcnt(1)
    v_and_b32 v132, s6, v115
    v_lshlrev_b32 v133, 16, v115
    v_mfma_f32_16x16x32_bf16 v[60:63], a[208:211], v[108:111], v[60:63]
    v_and_b32 v134, s6, v114
    v_lshlrev_b32 v135, 16, v114
    v_mfma_f32_16x16x32_bf16 v[56:59], a[176:179], v[108:111], v[56:59]
    v_mfma_f32_16x16x32_bf16 v[52:55], a[144:147], v[108:111], v[52:55]
    v_mfma_f32_16x16x32_bf16 v[48:51], a[112:115], v[108:111], v[48:51]
    v_mfma_f32_16x16x32_bf16 v[44:47], a[80:83], v[108:111], v[44:47]
    v_mfma_f32_16x16x32_bf16 v[40:43], a[48:51], v[108:111], v[40:43]
    v_mfma_f32_16x16x32_bf16 v[36:39], a[16:19], v[108:111], v[36:39]
    s_waitcnt lgkmcnt(4)
    v_mfma_f32_16x16x32_bf16 v[60:63], a[204:207], v[64:67], v[60:63]
    ds_read_b128 v[80:83], v7 offset:512
    ds_read_b64 v[112:113], v8 offset:768
    v_mfma_f32_16x16x32_bf16 v[56:59], a[172:175], v[64:67], v[56:59]
    ds_read_b128 v[84:87], v7 offset:2880
    v_mfma_f32_16x16x32_bf16 v[52:55], a[140:143], v[64:67], v[52:55]
    v_mfma_f32_16x16x32_bf16 v[48:51], a[108:111], v[64:67], v[48:51]
    v_mfma_f32_16x16x32_bf16 v[44:47], a[76:79], v[64:67], v[44:47]
    v_mfma_f32_16x16x32_bf16 v[40:43], a[44:47], v[64:67], v[40:43]
    v_mfma_f32_16x16x32_bf16 v[36:39], a[12:15], v[64:67], v[36:39]
    s_waitcnt lgkmcnt(1)
    v_and_b32 v136, s6, v113
    v_lshlrev_b32 v137, 16, v113
    v_mfma_f32_16x16x32_bf16 v[60:63], a[200:203], v[68:71], v[60:63]
    v_and_b32 v138, s6, v112
    v_lshlrev_b32 v139, 16, v112
    v_mfma_f32_16x16x32_bf16 v[56:59], a[168:171], v[68:71], v[56:59]
    v_mfma_f32_16x16x32_bf16 v[52:55], a[136:139], v[68:71], v[52:55]
    v_mfma_f32_16x16x32_bf16 v[48:51], a[104:107], v[68:71], v[48:51]
    v_mfma_f32_16x16x32_bf16 v[44:47], a[72:75], v[68:71], v[44:47]
    v_mfma_f32_16x16x32_bf16 v[40:43], a[40:43], v[68:71], v[40:43]
    v_mfma_f32_16x16x32_bf16 v[36:39], a[8:11], v[68:71], v[36:39]
    s_waitcnt lgkmcnt(3)
    v_mfma_f32_16x16x32_bf16 v[60:63], a[196:199], v[72:75], v[60:63]
    ds_read_b128 v[88:91], v7 offset:576
    v_mfma_f32_16x16x32_bf16 v[56:59], a[164:167], v[72:75], v[56:59]
    ds_read_b128 v[92:95], v7 offset:2944
    v_mfma_f32_16x16x32_bf16 v[52:55], a[132:135], v[72:75], v[52:55]
    v_mfma_f32_16x16x32_bf16 v[48:51], a[100:103], v[72:75], v[48:51]
    v_mfma_f32_16x16x32_bf16 v[44:47], a[68:71], v[72:75], v[44:47]
    v_mfma_f32_16x16x32_bf16 v[40:43], a[36:39], v[72:75], v[40:43]
    v_mfma_f32_16x16x32_bf16 v[36:39], a[4:7], v[72:75], v[36:39]
    v_mfma_f32_16x16x32_bf16 v[60:63], a[192:195], v[76:79], v[60:63]
    v_mfma_f32_16x16x32_bf16 v[56:59], a[160:163], v[76:79], v[56:59]
    v_mfma_f32_16x16x32_bf16 v[52:55], a[128:131], v[76:79], v[52:55]
    v_mfma_f32_16x16x32_bf16 v[48:51], a[96:99], v[76:79], v[48:51]
    v_mfma_f32_16x16x32_bf16 v[44:47], a[64:67], v[76:79], v[44:47]
    v_mfma_f32_16x16x32_bf16 v[40:43], a[32:35], v[76:79], v[40:43]
    v_mfma_f32_16x16x32_bf16 v[36:39], a[0:3], v[76:79], v[36:39]
    s_waitcnt lgkmcnt(2)
    v_mfma_f32_16x16x32_bf16 v[60:63], a[188:191], v[80:83], v[60:63]
    ds_read_b128 v[96:99], v7 offset:640
    v_mfma_f32_16x16x32_bf16 v[56:59], a[156:159], v[80:83], v[56:59]
    ds_read_b128 v[100:103], v7 offset:3008
    v_mfma_f32_16x16x32_bf16 v[52:55], a[124:127], v[80:83], v[52:55]
    v_mfma_f32_16x16x32_bf16 v[48:51], a[92:95], v[80:83], v[48:51]
    s_nop 0
    v_fmac_f32 v36, s67, v132
    v_fmac_f32 v37, s67, v133
    v_mfma_f32_16x16x32_bf16 v[44:47], a[60:63], v[80:83], v[44:47]
    v_fmac_f32 v38, s67, v134
    v_fmac_f32 v39, s67, v135
    v_mfma_f32_16x16x32_bf16 v[40:43], a[28:31], v[80:83], v[40:43]
    v_cvt_pk_bf16_f32 v126, v36, v37
    v_cvt_pk_bf16_f32 v127, v38, v39
    v_mfma_f32_16x16x32_bf16 v[60:63], a[184:187], v[84:87], v[60:63]
    ds_write_b64 v9, v[126:127] offset:2176
    s_lshl_b32 s69, s2, 7
    v_mfma_f32_16x16x32_bf16 v[56:59], a[152:155], v[84:87], v[56:59]
    s_add_u32 s69, s69, 6815744
    s_cmp_eq_u32 s3, 0
    s_cselect_b32 s69, s69, 8388608
    v_mfma_f32_16x16x32_bf16 v[52:55], a[120:123], v[84:87], v[52:55]
    v_mov_b32 v3, s92
    s_add_u32 s7, s73, 0
    v_mfma_f32_16x16x32_bf16 v[48:51], a[88:91], v[84:87], v[48:51]
    v_mfma_f32_16x16x32_bf16 v[44:47], a[56:59], v[84:87], v[44:47]
    v_mfma_f32_16x16x32_bf16 v[40:43], a[24:27], v[84:87], v[40:43]
    s_waitcnt lgkmcnt(3)
    v_mfma_f32_16x16x32_bf16 v[60:63], a[180:183], v[88:91], v[60:63]
    ds_read_b128 v[104:107], v7 offset:704
    v_mfma_f32_16x16x32_bf16 v[56:59], a[148:151], v[88:91], v[56:59]
    ds_read_b128 v[108:111], v7 offset:3072
    s_waitcnt vmcnt(0)
    s_waitcnt lgkmcnt(2)
    s_barrier
    ds_read_b128 v[116:119], v10 offset:0
    v_mfma_f32_16x16x32_bf16 v[52:55], a[116:119], v[88:91], v[52:55]
    v_mfma_f32_16x16x32_bf16 v[48:51], a[84:87], v[88:91], v[48:51]
    s_mov_b64 exec, 1
    buffer_store_dword v3, off, s[44:47], s69 sc1
    s_mov_b64 exec, -1
    v_mfma_f32_16x16x32_bf16 v[44:47], a[52:55], v[88:91], v[44:47]
    v_mfma_f32_16x16x32_bf16 v[40:43], a[20:23], v[88:91], v[40:43]
    v_mfma_f32_16x16x32_bf16 v[60:63], a[176:179], v[92:95], v[60:63]
    v_mfma_f32_16x16x32_bf16 v[56:59], a[144:147], v[92:95], v[56:59]
    v_mfma_f32_16x16x32_bf16 v[52:55], a[112:115], v[92:95], v[52:55]
    s_waitcnt lgkmcnt(0)
    buffer_store_dwordx4 v[116:119], v11, s[44:47], s7 offen sc1
    ds_read_b64 v[114:115], v8 offset:1024
    v_mfma_f32_16x16x32_bf16 v[48:51], a[80:83], v[92:95], v[48:51]
    v_mfma_f32_16x16x32_bf16 v[44:47], a[48:51], v[92:95], v[44:47]
    v_mfma_f32_16x16x32_bf16 v[40:43], a[16:19], v[92:95], v[40:43]
    s_waitcnt lgkmcnt(5)
    v_mfma_f32_16x16x32_bf16 v[60:63], a[172:175], v[96:99], v[60:63]
    ds_read_b128 v[64:67], v7 offset:768
    v_mfma_f32_16x16x32_bf16 v[56:59], a[140:143], v[96:99], v[56:59]
    ds_read_b128 v[68:71], v7 offset:3136
    v_mfma_f32_16x16x32_bf16 v[52:55], a[108:111], v[96:99], v[52:55]
    s_waitcnt lgkmcnt(2)
    v_and_b32 v140, s6, v115
    v_lshlrev_b32 v141, 16, v115
    v_mfma_f32_16x16x32_bf16 v[48:51], a[76:79], v[96:99], v[48:51]
    v_and_b32 v142, s6, v114
    v_lshlrev_b32 v143, 16, v114
    v_mfma_f32_16x16x32_bf16 v[44:47], a[44:47], v[96:99], v[44:47]
    buffer_load_dwordx4 v[16:19], v27, s[60:63], 0 offen
    v_mfma_f32_16x16x32_bf16 v[40:43], a[12:15], v[96:99], v[40:43]
    v_mfma_f32_16x16x32_bf16 v[60:63], a[168:171], v[100:103], v[60:63]
    buffer_load_dword v20, v13, s[60:63], 0 offen
    v_mfma_f32_16x16x32_bf16 v[56:59], a[136:139], v[100:103], v[56:59]
    v_mfma_f32_16x16x32_bf16 v[52:55], a[104:107], v[100:103], v[52:55]
    buffer_load_dwordx4 v[22:25], v27, s[60:63], 0 offen offset:1280
    v_mfma_f32_16x16x32_bf16 v[48:51], a[72:75], v[100:103], v[48:51]
    v_mfma_f32_16x16x32_bf16 v[44:47], a[40:43], v[100:103], v[44:47]
    buffer_load_dword v21, v13, s[60:63], 0 offen offset:1280
    v_mfma_f32_16x16x32_bf16 v[40:43], a[8:11], v[100:103], v[40:43]
    s_waitcnt lgkmcnt(4)
    v_mfma_f32_16x16x32_bf16 v[60:63], a[164:167], v[104:107], v[60:63]
    ds_read_b128 v[72:75], v7 offset:832
    v_lshlrev_b32 v2, 4, v1
    v_mfma_f32_16x16x32_bf16 v[56:59], a[132:135], v[104:107], v[56:59]
    ds_read_b128 v[76:79], v7 offset:3200
    global_load_dwordx4 v[28:31], v2, s[22:23]
    v_mfma_f32_16x16x32_bf16 v[52:55], a[100:103], v[104:107], v[52:55]
    v_mfma_f32_16x16x32_bf16 v[48:51], a[68:71], v[104:107], v[48:51]
    v_mfma_f32_16x16x32_bf16 v[44:47], a[36:39], v[104:107], v[44:47]
    v_lshlrev_b32 v2, 2, v1
    global_load_dword v26, v2, s[22:23] offset:1024
    v_mfma_f32_16x16x32_bf16 v[40:43], a[4:7], v[104:107], v[40:43]
    v_mfma_f32_16x16x32_bf16 v[60:63], a[160:163], v[108:111], v[60:63]
    v_mfma_f32_16x16x32_bf16 v[56:59], a[128:131], v[108:111], v[56:59]
    v_mfma_f32_16x16x32_bf16 v[52:55], a[96:99], v[108:111], v[52:55]
    v_mfma_f32_16x16x32_bf16 v[48:51], a[64:67], v[108:111], v[48:51]
    v_mfma_f32_16x16x32_bf16 v[44:47], a[32:35], v[108:111], v[44:47]
    v_mfma_f32_16x16x32_bf16 v[40:43], a[0:3], v[108:111], v[40:43]
    s_waitcnt lgkmcnt(2)
    v_mfma_f32_16x16x32_bf16 v[60:63], a[156:159], v[64:67], v[60:63]
    ds_read_b128 v[80:83], v7 offset:896
    v_mfma_f32_16x16x32_bf16 v[56:59], a[124:127], v[64:67], v[56:59]
    ds_read_b128 v[84:87], v7 offset:3264
    v_mfma_f32_16x16x32_bf16 v[52:55], a[92:95], v[64:67], v[52:55]
    ds_read_b128 v[88:91], v7 offset:960
    v_mfma_f32_16x16x32_bf16 v[48:51], a[60:63], v[64:67], v[48:51]
    ds_read_b128 v[92:95], v7 offset:3328
    v_fmac_f32 v40, s67, v136
    v_mfma_f32_16x16x32_bf16 v[44:47], a[28:31], v[64:67], v[44:47]
    v_fmac_f32 v41, s67, v137
    v_fmac_f32 v42, s67, v138
    v_mfma_f32_16x16x32_bf16 v[60:63], a[152:155], v[68:71], v[60:63]
    v_fmac_f32 v43, s67, v139
    v_cvt_pk_bf16_f32 v124, v40, v41
    v_mfma_f32_16x16x32_bf16 v[56:59], a[120:123], v[68:71], v[56:59]
    v_cvt_pk_bf16_f32 v125, v42, v43
    ds_write_b64 v9, v[124:125] offset:4352
    v_mfma_f32_16x16x32_bf16 v[52:55], a[88:91], v[68:71], v[52:55]
    v_mfma_f32_16x16x32_bf16 v[48:51], a[56:59], v[68:71], v[48:51]
    v_mfma_f32_16x16x32_bf16 v[44:47], a[24:27], v[68:71], v[44:47]
    s_waitcnt lgkmcnt(5)
    v_mfma_f32_16x16x32_bf16 v[60:63], a[148:151], v[72:75], v[60:63]
    v_mfma_f32_16x16x32_bf16 v[56:59], a[116:119], v[72:75], v[56:59]
    s_waitcnt vmcnt(12)
    v_max3_u32 v2, v172, v173, v174
    v_max3_u32 v2, v2, v175, v176
    v_mfma_f32_16x16x32_bf16 v[52:55], a[84:87], v[72:75], v[52:55]
    v_max3_u32 v2, v2, v177, v178
    v_max_u32 v2, v2, v179
    v_mfma_f32_16x16x32_bf16 v[48:51], a[52:55], v[72:75], v[48:51]
    v_mfma_f32_16x16x32_bf16 v[44:47], a[20:23], v[72:75], v[44:47]
    v_cmp_eq_u32 vcc, -1, v2
    s_cbranch_vccnz L_ub_slow
L_ub_ok:
    ds_write_b128 v6, v[172:175] offset:1280
    ds_write_b128 v6, v[176:179] offset:1792
    v_mfma_f32_16x16x32_bf16 v[60:63], a[144:147], v[76:79], v[60:63]
    v_mfma_f32_16x16x32_bf16 v[56:59], a[112:115], v[76:79], v[56:59]
    v_mfma_f32_16x16x32_bf16 v[52:55], a[80:83], v[76:79], v[52:55]
    v_mfma_f32_16x16x32_bf16 v[48:51], a[48:51], v[76:79], v[48:51]
    v_mfma_f32_16x16x32_bf16 v[44:47], a[16:19], v[76:79], v[44:47]
    s_waitcnt lgkmcnt(5)
    v_mfma_f32_16x16x32_bf16 v[60:63], a[140:143], v[80:83], v[60:63]
    ds_read_b128 v[96:99], v7 offset:1024
    ds_read_b64 v[112:113], v8 offset:1280
    v_mfma_f32_16x16x32_bf16 v[56:59], a[108:111], v[80:83], v[56:59]
    ds_read_b128 v[100:103], v7 offset:3392
    v_mfma_f32_16x16x32_bf16 v[52:55], a[76:79], v[80:83], v[52:55]
    ds_read_b128 v[104:107], v7 offset:1088
    v_mfma_f32_16x16x32_bf16 v[48:51], a[44:47], v[80:83], v[48:51]
    ds_read_b128 v[108:111], v7 offset:3456
    v_mfma_f32_16x16x32_bf16 v[44:47], a[12:15], v[80:83], v[44:47]
    ds_read_b128 v[64:67], v7 offset:1152
    v_mfma_f32_16x16x32_bf16 v[60:63], a[136:139], v[84:87], v[60:63]
    ds_read_b128 v[68:71], v7 offset:3520
    v_mfma_f32_16x16x32_bf16 v[56:59], a[104:107], v[84:87], v[56:59]
    ds_read_b128 v[72:75], v7 offset:1216
    s_waitcnt lgkmcnt(6)
    v_and_b32 v144, s6, v113
    v_mfma_f32_16x16x32_bf16 v[52:55], a[72:75], v[84:87], v[52:55]
    ds_read_b128 v[76:79], v7 offset:3584
    v_lshlrev_b32 v145, 16, v113
    v_mfma_f32_16x16x32_bf16 v[48:51], a[40:43], v[84:87], v[48:51]
    v_and_b32 v146, s6, v112
    v_lshlrev_b32 v147, 16, v112
    v_mfma_f32_16x16x32_bf16 v[44:47], a[8:11], v[84:87], v[44:47]
    s_waitcnt lgkmcnt(12)
    v_mfma_f32_16x16x32_bf16 v[60:63], a[132:135], v[88:91], v[60:63]
    ds_read_b128 v[80:83], v7 offset:1280
    ds_read_b64 v[114:115], v8 offset:1536
    v_mfma_f32_16x16x32_bf16 v[56:59], a[100:103], v[88:91], v[56:59]
    ds_read_b128 v[84:87], v7 offset:3648
    v_mfma_f32_16x16x32_bf16 v[52:55], a[68:71], v[88:91], v[52:55]
    v_mfma_f32_16x16x32_bf16 v[48:51], a[36:39], v[88:91], v[48:51]
    v_mfma_f32_16x16x32_bf16 v[44:47], a[4:7], v[88:91], v[44:47]
    v_mfma_f32_16x16x32_bf16 v[60:63], a[128:131], v[92:95], v[60:63]
    v_mfma_f32_16x16x32_bf16 v[56:59], a[96:99], v[92:95], v[56:59]
    s_waitcnt lgkmcnt(1)
    v_and_b32 v148, s6, v115
    v_lshlrev_b32 v149, 16, v115
    v_mfma_f32_16x16x32_bf16 v[52:55], a[64:67], v[92:95], v[52:55]
    v_and_b32 v150, s6, v114
    v_lshlrev_b32 v151, 16, v114
    v_mfma_f32_16x16x32_bf16 v[48:51], a[32:35], v[92:95], v[48:51]
    v_mfma_f32_16x16x32_bf16 v[44:47], a[0:3], v[92:95], v[44:47]
    s_waitcnt lgkmcnt(9)
    v_mfma_f32_16x16x32_bf16 v[60:63], a[124:127], v[96:99], v[60:63]
    ds_read_b128 v[88:91], v7 offset:1344
    v_mfma_f32_16x16x32_bf16 v[56:59], a[92:95], v[96:99], v[56:59]
    ds_read_b128 v[92:95], v7 offset:3712
    v_mfma_f32_16x16x32_bf16 v[52:55], a[60:63], v[96:99], v[52:55]
    v_mfma_f32_16x16x32_bf16 v[48:51], a[28:31], v[96:99], v[48:51]
    s_nop 0
    v_fmac_f32 v44, s67, v140
    v_fmac_f32 v45, s67, v141
    v_mfma_f32_16x16x32_bf16 v[60:63], a[120:123], v[100:103], v[60:63]
    v_fmac_f32 v46, s67, v142
    v_fmac_f32 v47, s67, v143
    v_mfma_f32_16x16x32_bf16 v[56:59], a[88:91], v[100:103], v[56:59]
    v_cvt_pk_bf16_f32 v126, v44, v45
    v_cvt_pk_bf16_f32 v127, v46, v47
    v_mfma_f32_16x16x32_bf16 v[52:55], a[56:59], v[100:103], v[52:55]
    ds_write_b64 v9, v[126:127] offset:6528
    s_add_u32 s7, s73, 655360
    v_mfma_f32_16x16x32_bf16 v[48:51], a[24:27], v[100:103], v[48:51]
    s_waitcnt lgkmcnt(10)
    v_mfma_f32_16x16x32_bf16 v[60:63], a[116:119], v[104:107], v[60:63]
    ds_read_b128 v[96:99], v7 offset:1408
    v_mfma_f32_16x16x32_bf16 v[56:59], a[84:87], v[104:107], v[56:59]
    ds_read_b128 v[100:103], v7 offset:3776
    v_mfma_f32_16x16x32_bf16 v[52:55], a[52:55], v[104:107], v[52:55]
    v_mfma_f32_16x16x32_bf16 v[48:51], a[20:23], v[104:107], v[48:51]
    s_waitcnt lgkmcnt(2)
    s_barrier
    ds_read_b128 v[120:123], v10 offset:4352
    v_mfma_f32_16x16x32_bf16 v[60:63], a[112:115], v[108:111], v[60:63]
    v_mfma_f32_16x16x32_bf16 v[56:59], a[80:83], v[108:111], v[56:59]
    v_mfma_f32_16x16x32_bf16 v[52:55], a[48:51], v[108:111], v[52:55]
    v_mfma_f32_16x16x32_bf16 v[48:51], a[16:19], v[108:111], v[48:51]
    s_waitcnt lgkmcnt(11)
    v_mfma_f32_16x16x32_bf16 v[60:63], a[108:111], v[64:67], v[60:63]
    ds_read_b128 v[104:107], v7 offset:1472
    s_waitcnt lgkmcnt(1)
    buffer_store_dwordx4 v[120:123], v11, s[44:47], s7 offen sc1
    v_mfma_f32_16x16x32_bf16 v[56:59], a[76:79], v[64:67], v[56:59]
    ds_read_b128 v[108:111], v7 offset:3840
    ds_read_b64 v[112:113], v8 offset:1792
    v_mfma_f32_16x16x32_bf16 v[52:55], a[44:47], v[64:67], v[52:55]
    v_mfma_f32_16x16x32_bf16 v[48:51], a[12:15], v[64:67], v[48:51]
    v_mfma_f32_16x16x32_bf16 v[60:63], a[104:107], v[68:71], v[60:63]
    v_mfma_f32_16x16x32_bf16 v[56:59], a[72:75], v[68:71], v[56:59]
    v_mfma_f32_16x16x32_bf16 v[52:55], a[40:43], v[68:71], v[52:55]
    v_mfma_f32_16x16x32_bf16 v[48:51], a[8:11], v[68:71], v[48:51]
    s_waitcnt lgkmcnt(0)
    v_and_b32 v152, s6, v113
    v_lshlrev_b32 v153, 16, v113
    s_waitcnt lgkmcnt(12)
    v_mfma_f32_16x16x32_bf16 v[60:63], a[100:103], v[72:75], v[60:63]
    ds_read_b128 v[64:67], v7 offset:1536
    v_and_b32 v154, s6, v112
    v_mfma_f32_16x16x32_bf16 v[56:59], a[68:71], v[72:75], v[56:59]
    ds_read_b128 v[68:71], v7 offset:3904
    v_lshlrev_b32 v155, 16, v112
    v_mfma_f32_16x16x32_bf16 v[52:55], a[36:39], v[72:75], v[52:55]
    ds_read_b64 v[114:115], v8 offset:2048
    v_mfma_f32_16x16x32_bf16 v[48:51], a[4:7], v[72:75], v[48:51]
    v_mfma_f32_16x16x32_bf16 v[60:63], a[96:99], v[76:79], v[60:63]
    v_mfma_f32_16x16x32_bf16 v[56:59], a[64:67], v[76:79], v[56:59]
    v_mfma_f32_16x16x32_bf16 v[52:55], a[32:35], v[76:79], v[52:55]
    v_mfma_f32_16x16x32_bf16 v[48:51], a[0:3], v[76:79], v[48:51]
    s_waitcnt lgkmcnt(0)
    v_and_b32 v156, s6, v115
    v_lshlrev_b32 v157, 16, v115
    s_waitcnt lgkmcnt(12)
    v_mfma_f32_16x16x32_bf16 v[60:63], a[92:95], v[80:83], v[60:63]
    ds_read_b128 v[72:75], v7 offset:1600
    v_and_b32 v158, s6, v114
    v_mfma_f32_16x16x32_bf16 v[56:59], a[60:63], v[80:83], v[56:59]
    ds_read_b128 v[76:79], v7 offset:3968
    v_lshlrev_b32 v159, 16, v114
    v_mfma_f32_16x16x32_bf16 v[52:55], a[28:31], v[80:83], v[52:55]
    v_mfma_f32_16x16x32_bf16 v[60:63], a[88:91], v[84:87], v[60:63]
    v_mfma_f32_16x16x32_bf16 v[56:59], a[56:59], v[84:87], v[56:59]
    v_mfma_f32_16x16x32_bf16 v[52:55], a[24:27], v[84:87], v[52:55]
    v_fmac_f32 v48, s67, v144
    v_fmac_f32 v49, s67, v145
    s_waitcnt lgkmcnt(12)
    v_mfma_f32_16x16x32_bf16 v[60:63], a[84:87], v[88:91], v[60:63]
    ds_read_b128 v[80:83], v7 offset:1664
    v_fmac_f32 v50, s67, v146
    v_mfma_f32_16x16x32_bf16 v[56:59], a[52:55], v[88:91], v[56:59]
    ds_read_b128 v[84:87], v7 offset:4032
    v_fmac_f32 v51, s67, v147
    v_mfma_f32_16x16x32_bf16 v[52:55], a[20:23], v[88:91], v[52:55]
    v_cvt_pk_bf16_f32 v124, v48, v49
    v_cvt_pk_bf16_f32 v125, v50, v51
    v_mfma_f32_16x16x32_bf16 v[60:63], a[80:83], v[92:95], v[60:63]
    ds_write_b64 v9, v[124:125] offset:8704
    v_mfma_f32_16x16x32_bf16 v[56:59], a[48:51], v[92:95], v[56:59]
    v_mfma_f32_16x16x32_bf16 v[52:55], a[16:19], v[92:95], v[52:55]
    s_waitcnt lgkmcnt(12)
    v_mfma_f32_16x16x32_bf16 v[60:63], a[76:79], v[96:99], v[60:63]
    ds_read_b128 v[88:91], v7 offset:1728
    v_mfma_f32_16x16x32_bf16 v[56:59], a[44:47], v[96:99], v[56:59]
    ds_read_b128 v[92:95], v7 offset:4096
    v_mfma_f32_16x16x32_bf16 v[52:55], a[12:15], v[96:99], v[52:55]
    v_mfma_f32_16x16x32_bf16 v[60:63], a[72:75], v[100:103], v[60:63]
    v_mfma_f32_16x16x32_bf16 v[56:59], a[40:43], v[100:103], v[56:59]
    v_mfma_f32_16x16x32_bf16 v[52:55], a[8:11], v[100:103], v[52:55]
    s_waitcnt lgkmcnt(11)
    v_mfma_f32_16x16x32_bf16 v[60:63], a[68:71], v[104:107], v[60:63]
    ds_read_b128 v[96:99], v7 offset:1792
    v_mfma_f32_16x16x32_bf16 v[56:59], a[36:39], v[104:107], v[56:59]
    ds_read_b128 v[100:103], v7 offset:4160
    v_mfma_f32_16x16x32_bf16 v[52:55], a[4:7], v[104:107], v[52:55]
    v_mfma_f32_16x16x32_bf16 v[60:63], a[64:67], v[108:111], v[60:63]
    v_mfma_f32_16x16x32_bf16 v[56:59], a[32:35], v[108:111], v[56:59]
    v_mfma_f32_16x16x32_bf16 v[52:55], a[0:3], v[108:111], v[52:55]
    s_waitcnt lgkmcnt(10)
    v_mfma_f32_16x16x32_bf16 v[60:63], a[60:63], v[64:67], v[60:63]
    ds_read_b128 v[104:107], v7 offset:1856
    v_mfma_f32_16x16x32_bf16 v[56:59], a[28:31], v[64:67], v[56:59]
    ds_read_b128 v[108:111], v7 offset:4224
    v_mfma_f32_16x16x32_bf16 v[60:63], a[56:59], v[68:71], v[60:63]
    s_nop 1
    v_fmac_f32 v52, s67, v148
    v_fmac_f32 v53, s67, v149
    v_mfma_f32_16x16x32_bf16 v[56:59], a[24:27], v[68:71], v[56:59]
    v_fmac_f32 v54, s67, v150
    v_fmac_f32 v55, s67, v151
    s_waitcnt lgkmcnt(9)
    v_mfma_f32_16x16x32_bf16 v[60:63], a[52:55], v[72:75], v[60:63]
    ds_read_b128 v[64:67], v7 offset:1920
    v_cvt_pk_bf16_f32 v126, v52, v53
    v_mfma_f32_16x16x32_bf16 v[56:59], a[20:23], v[72:75], v[56:59]
    ds_read_b128 v[68:71], v7 offset:4288
    v_cvt_pk_bf16_f32 v127, v54, v55
    v_mfma_f32_16x16x32_bf16 v[60:63], a[48:51], v[76:79], v[60:63]
    ds_write_b64 v9, v[126:127] offset:10880
    s_add_u32 s7, s73, 1310720
    v_mfma_f32_16x16x32_bf16 v[56:59], a[16:19], v[76:79], v[56:59]
    s_waitcnt lgkmcnt(10)
    v_mfma_f32_16x16x32_bf16 v[60:63], a[44:47], v[80:83], v[60:63]
    ds_read_b128 v[72:75], v7 offset:1984
    v_mfma_f32_16x16x32_bf16 v[56:59], a[12:15], v[80:83], v[56:59]
    ds_read_b128 v[76:79], v7 offset:4352
    v_mfma_f32_16x16x32_bf16 v[60:63], a[40:43], v[84:87], v[60:63]
    s_waitcnt lgkmcnt(2)
    s_barrier
    ds_read_b128 v[116:119], v10 offset:8704
    v_mfma_f32_16x16x32_bf16 v[56:59], a[8:11], v[84:87], v[56:59]
    s_waitcnt lgkmcnt(10)
    v_mfma_f32_16x16x32_bf16 v[60:63], a[36:39], v[88:91], v[60:63]
    v_mfma_f32_16x16x32_bf16 v[56:59], a[4:7], v[88:91], v[56:59]
    v_mfma_f32_16x16x32_bf16 v[60:63], a[32:35], v[92:95], v[60:63]
    s_waitcnt lgkmcnt(0)
    buffer_store_dwordx4 v[116:119], v11, s[44:47], s7 offen sc1
    v_mfma_f32_16x16x32_bf16 v[56:59], a[0:3], v[92:95], v[56:59]
    s_waitcnt lgkmcnt(8)
    v_mfma_f32_16x16x32_bf16 v[60:63], a[28:31], v[96:99], v[60:63]
    v_mfma_f32_16x16x32_bf16 v[60:63], a[24:27], v[100:103], v[60:63]
    s_waitcnt lgkmcnt(6)
    v_mfma_f32_16x16x32_bf16 v[60:63], a[20:23], v[104:107], v[60:63]
    s_nop 2
    v_fmac_f32 v56, s67, v152
    v_fmac_f32 v57, s67, v153
    v_mfma_f32_16x16x32_bf16 v[60:63], a[16:19], v[108:111], v[60:63]
    v_fmac_f32 v58, s67, v154
    v_fmac_f32 v59, s67, v155
    s_waitcnt lgkmcnt(4)
    v_mfma_f32_16x16x32_bf16 v[60:63], a[12:15], v[64:67], v[60:63]
    v_cvt_pk_bf16_f32 v124, v56, v57
    v_cvt_pk_bf16_f32 v125, v58, v59
    v_mfma_f32_16x16x32_bf16 v[60:63], a[8:11], v[68:71], v[60:63]
    ds_write_b64 v9, v[124:125] offset:13056
    s_waitcnt lgkmcnt(2)
    v_mfma_f32_16x16x32_bf16 v[60:63], a[4:7], v[72:75], v[60:63]
    v_mfma_f32_16x16x32_bf16 v[60:63], a[0:3], v[76:79], v[60:63]
    s_nop 7
    v_fmac_f32 v60, s67, v156
    v_fmac_f32 v61, s67, v157
    v_fmac_f32 v62, s67, v158
    v_fmac_f32 v63, s67, v159
    v_cvt_pk_bf16_f32 v126, v60, v61
    v_cvt_pk_bf16_f32 v127, v62, v63
    ds_write_b64 v9, v[126:127] offset:15232
    s_add_u32 s7, s73, 1966080
    s_waitcnt lgkmcnt(0)
    s_barrier
    ds_read_b128 v[120:123], v10 offset:13056
    s_waitcnt lgkmcnt(0)
    buffer_store_dwordx4 v[120:123], v11, s[44:47], s7 offen sc1
    s_waitcnt vmcnt(3)
    s_branch L_p2
L_nc_start:
    s_mov_b32 s48, s24
    s_mov_b32 s49, s25
    s_mov_b32 s50, 1966080
    s_mov_b32 s51, 0x00020000
    s_mul_i32 s70, s64, 2560
    s_add_u32 s70, s70, 5308416
    v_mov_b32 v13, s70
    s_lshl_b32 s7, s64, 7
    s_lshl_b32 s69, s64, 7
    s_add_u32 s69, s69, 5259264 - 2560
    v_mov_b32 v2, s69
    v_cmp_eq_u32 vcc, 20, v5
    s_nop 1
    v_cndmask_b32 v13, v13, v2, vcc
    s_add_u32 s69, s7, 6684672 - 2688
    v_mov_b32 v2, s69
    v_cmp_eq_u32 vcc, 21, v5
    s_nop 1
    v_cndmask_b32 v13, v13, v2, vcc
    s_lshl_b32 s7, s74, 7
    s_add_u32 s69, s7, 6619136 - 2816
    s_cmp_lt_u32 s85, 6
    s_cselect_b32 s69, s69, 8388608
    v_mov_b32 v2, s69
    v_cmp_eq_u32 vcc, 22, v5
    s_nop 1
    v_cndmask_b32 v13, v13, v2, vcc
    v_mov_b32 v2, 8388608
    v_cmp_lt_u32 vcc, 22, v5
    s_nop 1
    v_cndmask_b32 v13, v13, v2, vcc
    v_lshl_add_u32 v13, v0, 4, v13
    buffer_store_dwordx4 v[252:255], v13, s[44:47], 0 offen sc1
    s_cmp_ge_u32 s2, 240
    s_cbranch_scc1 L_nc_nop0
    s_mov_b32 s60, s8
    s_mov_b32 s61, s9
    s_mov_b32 s62, 2621440
    s_mov_b32 s63, 0x00020000
    s_mov_b32 s52, s30
    s_mov_b32 s53, s31
    s_mov_b32 s54, 2621440
    s_mov_b32 s55, 0x00020000
    s_lshl_b32 s69, s64, 2
    s_add_u32 s69, s69, s3
    s_mul_i32 s69, s69, 2560
    v_lshl_add_u32 v27, v1, 4, s69
    s_add_u32 s69, s69, 1024
    v_lshl_add_u32 v13, v1, 2, s69
    s_waitcnt vmcnt(12)
    s_barrier
    s_lshl_b32 s7, s2, 7
    s_add_u32 s7, s7, 6750208
    s_cmp_eq_u32 s3, 0
    s_cselect_b32 s7, s7, 8388608
    v_mov_b32 v2, s92
    s_mov_b64 exec, 1
    buffer_store_dword v2, off, s[44:47], s7 sc1
    s_mov_b64 exec, -1
    buffer_load_dwordx4 v[196:199], v6, s[40:43], s71 offen
    buffer_load_dwordx4 v[200:203], v6, s[40:43], s71 offen offset:1280
    buffer_load_dwordx4 v[188:191], v6, s[36:39], s71 offen
    buffer_load_dwordx4 v[192:195], v6, s[36:39], s71 offen offset:1280
    buffer_load_dwordx4 v[176:179], v8, s[36:39], s71 offen
    buffer_load_dwordx4 v[180:183], v7, s[36:39], s71 offen
    buffer_load_dwordx4 v[184:187], v7, s[36:39], s71 offen offset:1280
    s_waitcnt vmcnt(16)
    v_and_b32 v220, 0xffff, v204
    v_lshrrev_b32 v221, 16, v204
    v_and_b32 v222, 0xffff, v205
    v_lshrrev_b32 v223, 16, v205
    v_lshlrev_b32 v224, 16, v206
    v_and_b32 v225, s6, v206
    v_lshlrev_b32 v226, 16, v207
    v_and_b32 v227, s6, v207
    v_and_b32 v228, 0xffff, v208
    v_lshrrev_b32 v229, 16, v208
    v_and_b32 v230, 0xffff, v209
    v_lshrrev_b32 v231, 16, v209
    v_lshlrev_b32 v232, 16, v210
    v_and_b32 v233, s6, v210
    v_lshlrev_b32 v234, 16, v211
    v_and_b32 v235, s6, v211
    v_and_b32 v236, 0xffff, v212
    v_lshrrev_b32 v237, 16, v212
    v_and_b32 v238, 0xffff, v213
    v_lshrrev_b32 v239, 16, v213
    v_lshlrev_b32 v240, 16, v214
    v_and_b32 v241, s6, v214
    v_lshlrev_b32 v242, 16, v215
    v_and_b32 v243, s6, v215
    v_and_b32 v244, 0xffff, v216
    v_lshrrev_b32 v245, 16, v216
    v_and_b32 v246, 0xffff, v217
    v_lshrrev_b32 v247, 16, v217
    v_lshlrev_b32 v248, 16, v218
    v_and_b32 v249, s6, v218
    v_lshlrev_b32 v250, 16, v219
    v_and_b32 v251, s6, v219
    v_xor_b32 v2, 3, v5
    v_lshrrev_b32 v3, 2, v5
    v_xor_b32 v3, v3, v4
    v_and_b32 v2, 3, v2
    v_lshlrev_b32 v2, 2, v2
    v_lshl_add_u32 v2, v3, 4, v2
    v_add_u32 v2, 87552, v2
    v_lshl_add_u32 v6, v4, 10, v2
    v_xor_b32 v3, s3, v4
    v_lshlrev_b32 v2, 7, v5
    v_add_u32 v2, 87552, v2
    v_lshl_add_u32 v7, v3, 4, v2
    v_xor_b32 v3, 4, v3
    v_lshl_add_u32 v8, v3, 4, v2
    s_waitcnt vmcnt(9)
    v_dot2_f32_bf16 v32, v160, v220, 0
    v_dot2_f32_bf16 v33, v164, v220, 0
    v_dot2_f32_bf16 v34, v160, v224, 0
    v_dot2_f32_bf16 v35, v164, v224, 0
    v_dot2_f32_bf16 v36, v161, v228, 0
    v_dot2_f32_bf16 v37, v165, v228, 0
    v_dot2_f32_bf16 v38, v161, v232, 0
    v_dot2_f32_bf16 v39, v165, v232, 0
    v_dot2c_f32_bf16 v32, v156, v221
    v_dot2c_f32_bf16 v33, v160, v221
    v_dot2c_f32_bf16 v34, v156, v225
    v_dot2c_f32_bf16 v35, v160, v225
    v_dot2c_f32_bf16 v36, v157, v229
    v_dot2c_f32_bf16 v37, v161, v229
    v_dot2c_f32_bf16 v38, v157, v233
    v_dot2c_f32_bf16 v39, v161, v233
    v_dot2c_f32_bf16 v32, v152, v222
    v_dot2c_f32_bf16 v33, v156, v222
    v_dot2c_f32_bf16 v34, v152, v226
    v_dot2c_f32_bf16 v35, v156, v226
    v_dot2c_f32_bf16 v36, v153, v230
    v_dot2c_f32_bf16 v37, v157, v230
    v_dot2c_f32_bf16 v38, v153, v234
    v_dot2c_f32_bf16 v39, v157, v234
    v_dot2c_f32_bf16 v32, v148, v223
    v_dot2c_f32_bf16 v33, v152, v223
    v_dot2c_f32_bf16 v34, v148, v227
    v_dot2c_f32_bf16 v35, v152, v227
    v_dot2c_f32_bf16 v36, v149, v231
    v_dot2c_f32_bf16 v37, v153, v231
    v_dot2c_f32_bf16 v38, v149, v235
    v_dot2c_f32_bf16 v39, v153, v235
    v_lshlrev_b32 v52, 16, v168
    v_lshlrev_b32 v53, 16, v172
    v_and_b32 v54, s6, v168
    v_and_b32 v55, s6, v172
    v_lshlrev_b32 v56, 16, v169
    v_lshlrev_b32 v57, 16, v173
    v_and_b32 v58, s6, v169
    v_and_b32 v59, s6, v173
    v_mul_f32 v32, v32, v52
    v_mul_f32 v33, v33, v53
    v_mul_f32 v34, v34, v54
    v_mul_f32 v35, v35, v55
    v_mul_f32 v36, v36, v56
    v_mul_f32 v37, v37, v57
    v_mul_f32 v38, v38, v58
    v_mul_f32 v39, v39, v59
    v_cvt_pk_bf16_f32 v32, v33, v32
    ds_write_b32 v6, v32 offset:0
    v_cvt_pk_bf16_f32 v34, v35, v34
    ds_write_b32 v6, v34 offset:128
    v_cvt_pk_bf16_f32 v36, v37, v36
    ds_write_b32 v6, v36 offset:256
    v_cvt_pk_bf16_f32 v38, v39, v38
    ds_write_b32 v6, v38 offset:384
    v_dot2_f32_bf16 v40, v162, v236, 0
    v_dot2_f32_bf16 v41, v166, v236, 0
    v_dot2_f32_bf16 v42, v162, v240, 0
    v_dot2_f32_bf16 v43, v166, v240, 0
    v_dot2_f32_bf16 v44, v163, v244, 0
    v_dot2_f32_bf16 v45, v167, v244, 0
    v_dot2_f32_bf16 v46, v163, v248, 0
    v_dot2_f32_bf16 v47, v167, v248, 0
    v_dot2c_f32_bf16 v40, v158, v237
    v_dot2c_f32_bf16 v41, v162, v237
    v_dot2c_f32_bf16 v42, v158, v241
    v_dot2c_f32_bf16 v43, v162, v241
    v_dot2c_f32_bf16 v44, v159, v245
    v_dot2c_f32_bf16 v45, v163, v245
    v_dot2c_f32_bf16 v46, v159, v249
    v_dot2c_f32_bf16 v47, v163, v249
    v_dot2c_f32_bf16 v40, v154, v238
    v_dot2c_f32_bf16 v41, v158, v238
    v_dot2c_f32_bf16 v42, v154, v242
    v_dot2c_f32_bf16 v43, v158, v242
    v_dot2c_f32_bf16 v44, v155, v246
    v_dot2c_f32_bf16 v45, v159, v246
    v_dot2c_f32_bf16 v46, v155, v250
    v_dot2c_f32_bf16 v47, v159, v250
    v_dot2c_f32_bf16 v40, v150, v239
    v_dot2c_f32_bf16 v41, v154, v239
    v_dot2c_f32_bf16 v42, v150, v243
    v_dot2c_f32_bf16 v43, v154, v243
    v_dot2c_f32_bf16 v44, v151, v247
    v_dot2c_f32_bf16 v45, v155, v247
    v_dot2c_f32_bf16 v46, v151, v251
    v_dot2c_f32_bf16 v47, v155, v251
    v_lshlrev_b32 v52, 16, v170
    v_lshlrev_b32 v53, 16, v174
    v_and_b32 v54, s6, v170
    v_and_b32 v55, s6, v174
    v_lshlrev_b32 v56, 16, v171
    v_lshlrev_b32 v57, 16, v175
    v_and_b32 v58, s6, v171
    v_and_b32 v59, s6, v175
    v_mul_f32 v40, v40, v52
    v_mul_f32 v41, v41, v53
    v_mul_f32 v42, v42, v54
    v_mul_f32 v43, v43, v55
    v_mul_f32 v44, v44, v56
    v_mul_f32 v45, v45, v57
    v_mul_f32 v46, v46, v58
    v_mul_f32 v47, v47, v59
    v_cvt_pk_bf16_f32 v40, v41, v40
    ds_write_b32 v6, v40 offset:512
    v_cvt_pk_bf16_f32 v42, v43, v42
    ds_write_b32 v6, v42 offset:640
    v_cvt_pk_bf16_f32 v44, v45, v44
    ds_write_b32 v6, v44 offset:768
    v_cvt_pk_bf16_f32 v46, v47, v46
    ds_write_b32 v6, v46 offset:896
    s_waitcnt vmcnt(0)
    v_dot2_f32_bf16 v32, v188, v220, 0
    v_dot2_f32_bf16 v33, v192, v220, 0
    v_dot2_f32_bf16 v34, v188, v224, 0
    v_dot2_f32_bf16 v35, v192, v224, 0
    v_dot2_f32_bf16 v36, v189, v228, 0
    v_dot2_f32_bf16 v37, v193, v228, 0
    v_dot2_f32_bf16 v38, v189, v232, 0
    v_dot2_f32_bf16 v39, v193, v232, 0
    v_dot2c_f32_bf16 v32, v184, v221
    v_dot2c_f32_bf16 v33, v188, v221
    v_dot2c_f32_bf16 v34, v184, v225
    v_dot2c_f32_bf16 v35, v188, v225
    v_dot2c_f32_bf16 v36, v185, v229
    v_dot2c_f32_bf16 v37, v189, v229
    v_dot2c_f32_bf16 v38, v185, v233
    v_dot2c_f32_bf16 v39, v189, v233
    v_dot2c_f32_bf16 v32, v180, v222
    v_dot2c_f32_bf16 v33, v184, v222
    v_dot2c_f32_bf16 v34, v180, v226
    v_dot2c_f32_bf16 v35, v184, v226
    v_dot2c_f32_bf16 v36, v181, v230
    v_dot2c_f32_bf16 v37, v185, v230
    v_dot2c_f32_bf16 v38, v181, v234
    v_dot2c_f32_bf16 v39, v185, v234
    v_dot2c_f32_bf16 v32, v176, v223
    v_dot2c_f32_bf16 v33, v180, v223
    v_dot2c_f32_bf16 v34, v176, v227
    v_dot2c_f32_bf16 v35, v180, v227
    v_dot2c_f32_bf16 v36, v177, v231
    v_dot2c_f32_bf16 v37, v181, v231
    v_dot2c_f32_bf16 v38, v177, v235
    v_dot2c_f32_bf16 v39, v181, v235
    v_lshlrev_b32 v52, 16, v196
    v_lshlrev_b32 v53, 16, v200
    v_and_b32 v54, s6, v196
    v_and_b32 v55, s6, v200
    v_lshlrev_b32 v56, 16, v197
    v_lshlrev_b32 v57, 16, v201
    v_and_b32 v58, s6, v197
    v_and_b32 v59, s6, v201
    v_mul_f32 v32, v32, v52
    v_mul_f32 v33, v33, v53
    v_mul_f32 v34, v34, v54
    v_mul_f32 v35, v35, v55
    v_mul_f32 v36, v36, v56
    v_mul_f32 v37, v37, v57
    v_mul_f32 v38, v38, v58
    v_mul_f32 v39, v39, v59
    v_cvt_pk_bf16_f32 v32, v33, v32
    ds_write_b32 v6, v32 offset:8192
    v_cvt_pk_bf16_f32 v34, v35, v34
    ds_write_b32 v6, v34 offset:8320
    v_cvt_pk_bf16_f32 v36, v37, v36
    ds_write_b32 v6, v36 offset:8448
    v_cvt_pk_bf16_f32 v38, v39, v38
    ds_write_b32 v6, v38 offset:8576
    v_dot2_f32_bf16 v40, v190, v236, 0
    v_dot2_f32_bf16 v41, v194, v236, 0
    v_dot2_f32_bf16 v42, v190, v240, 0
    v_dot2_f32_bf16 v43, v194, v240, 0
    v_dot2_f32_bf16 v44, v191, v244, 0
    v_dot2_f32_bf16 v45, v195, v244, 0
    v_dot2_f32_bf16 v46, v191, v248, 0
    v_dot2_f32_bf16 v47, v195, v248, 0
    v_dot2c_f32_bf16 v40, v186, v237
    v_dot2c_f32_bf16 v41, v190, v237
    v_dot2c_f32_bf16 v42, v186, v241
    v_dot2c_f32_bf16 v43, v190, v241
    v_dot2c_f32_bf16 v44, v187, v245
    v_dot2c_f32_bf16 v45, v191, v245
    v_dot2c_f32_bf16 v46, v187, v249
    v_dot2c_f32_bf16 v47, v191, v249
    v_dot2c_f32_bf16 v40, v182, v238
    v_dot2c_f32_bf16 v41, v186, v238
    v_dot2c_f32_bf16 v42, v182, v242
    v_dot2c_f32_bf16 v43, v186, v242
    v_dot2c_f32_bf16 v44, v183, v246
    v_dot2c_f32_bf16 v45, v187, v246
    v_dot2c_f32_bf16 v46, v183, v250
    v_dot2c_f32_bf16 v47, v187, v250
    v_dot2c_f32_bf16 v40, v178, v239
    v_dot2c_f32_bf16 v41, v182, v239
    v_dot2c_f32_bf16 v42, v178, v243
    v_dot2c_f32_bf16 v43, v182, v243
    v_dot2c_f32_bf16 v44, v179, v247
    v_dot2c_f32_bf16 v45, v183, v247
    v_dot2c_f32_bf16 v46, v179, v251
    v_dot2c_f32_bf16 v47, v183, v251
    v_lshlrev_b32 v52, 16, v198
    v_lshlrev_b32 v53, 16, v202
    v_and_b32 v54, s6, v198
    v_and_b32 v55, s6, v202
    v_lshlrev_b32 v56, 16, v199
    v_lshlrev_b32 v57, 16, v203
    v_and_b32 v58, s6, v199
    v_and_b32 v59, s6, v203
    v_mul_f32 v40, v40, v52
    v_mul_f32 v41, v41, v53
    v_mul_f32 v42, v42, v54
    v_mul_f32 v43, v43, v55
    v_mul_f32 v44, v44, v56
    v_mul_f32 v45, v45, v57
    v_mul_f32 v46, v46, v58
    v_mul_f32 v47, v47, v59
    v_cvt_pk_bf16_f32 v40, v41, v40
    ds_write_b32 v6, v40 offset:8704
    v_cvt_pk_bf16_f32 v42, v43, v42
    ds_write_b32 v6, v42 offset:8832
    v_cvt_pk_bf16_f32 v44, v45, v44
    ds_write_b32 v6, v44 offset:8960
    v_cvt_pk_bf16_f32 v46, v47, v46
    ds_write_b32 v6, v46 offset:9088
    s_waitcnt lgkmcnt(0)
    s_barrier
    ds_read_b128 v[60:63], v7 offset:0
    ds_read_b128 v[64:67], v8 offset:4096
    ds_read_b128 v[68:71], v7 offset:8192
    ds_read_b128 v[72:75], v8 offset:12288
    s_lshl_b32 s7, s2, 7
    s_add_u32 s7, s7, 6815744
    s_cmp_eq_u32 s3, 0
    s_cselect_b32 s7, s7, 8388608
    v_mov_b32 v2, s92
    s_mov_b64 exec, 1
    buffer_store_dword v2, off, s[44:47], s7 sc1
    s_mov_b64 exec, -1
    s_waitcnt lgkmcnt(2)
    s_add_u32 s7, s72, 0
    buffer_store_dwordx4 v[60:63], v14, s[44:47], s7 offen sc1
    s_add_u32 s7, s72, 131072
    buffer_store_dwordx4 v[64:67], v14, s[44:47], s7 offen sc1
    s_waitcnt lgkmcnt(0)
    s_add_u32 s7, s72, 128
    buffer_store_dwordx4 v[68:71], v14, s[44:47], s7 offen sc1
    s_add_u32 s7, s72, 131200
    buffer_store_dwordx4 v[72:75], v14, s[44:47], s7 offen sc1
    buffer_load_dwordx4 v[16:19], v27, s[60:63], 0 offen
    buffer_load_dword v20, v13, s[60:63], 0 offen
    buffer_load_dwordx4 v[22:25], v27, s[60:63], 0 offen offset:1280
    buffer_load_dword v21, v13, s[60:63], 0 offen offset:1280
    v_lshlrev_b32 v2, 4, v1
    global_load_dwordx4 v[28:31], v2, s[22:23]
    v_lshlrev_b32 v2, 2, v1
    global_load_dword v26, v2, s[22:23] offset:1024
    s_branch L_nc_w
L_nc_nop0:
    s_mov_b32 s60, s8
    s_mov_b32 s61, s9
    s_mov_b32 s62, 2621440
    s_mov_b32 s63, 0x00020000
    s_mov_b32 s52, s30
    s_mov_b32 s53, s31
    s_mov_b32 s54, 2621440
    s_mov_b32 s55, 0x00020000
    s_lshl_b32 s69, s64, 2
    s_add_u32 s69, s69, s3
    s_mul_i32 s69, s69, 2560
    v_lshl_add_u32 v27, v1, 4, s69
    s_add_u32 s69, s69, 1024
    v_lshl_add_u32 v13, v1, 2, s69
    buffer_load_dwordx4 v[16:19], v27, s[60:63], 0 offen
    buffer_load_dword v20, v13, s[60:63], 0 offen
    buffer_load_dwordx4 v[22:25], v27, s[60:63], 0 offen offset:1280
    buffer_load_dword v21, v13, s[60:63], 0 offen offset:1280
    v_lshlrev_b32 v2, 4, v1
    global_load_dwordx4 v[28:31], v2, s[22:23]
    v_lshlrev_b32 v2, 2, v1
    global_load_dword v26, v2, s[22:23] offset:1024
    s_waitcnt vmcnt(6)
    s_barrier
    s_lshl_b32 s7, s2, 7
    s_add_u32 s7, s7, 6815744
    s_cmp_eq_u32 s3, 0
    s_cselect_b32 s7, s7, 8388608
    v_mov_b32 v2, s92
    s_mov_b64 exec, 1
    buffer_store_dword v2, off, s[44:47], s7 sc1
    s_mov_b64 exec, -1
    s_mul_i32 s7, s4, 160
    s_and_b32 s7, s7, 0xffffff80
    s_sub_u32 s69, s85, 10
    s_mul_i32 s69, s69, 655360
    s_add_u32 s7, s7, s69
    v_lshrrev_b32 v110, 1, v0
    v_and_b32 v111, 1, v0
    v_mul_u32_u24 v110, 1280, v110
    v_lshl_add_u32 v110, v111, 7, v110
    buffer_load_dword v108, v110, s[88:91], s7 offen
    s_add_u32 s7, s7, 163840
    buffer_load_dword v108, v110, s[88:91], s7 offen
    s_add_u32 s7, s7, 163840
    buffer_load_dword v108, v110, s[88:91], s7 offen
    s_add_u32 s7, s7, 163840
    buffer_load_dword v108, v110, s[88:91], s7 offen
    s_waitcnt vmcnt(5)
    s_branch L_p2
L_nc_w:
    s_waitcnt vmcnt(0)
L_p2:
    v_lshlrev_b32 v14, 7, v0
    s_mov_b32 s71, 6815744
    buffer_load_dword v12, v14, s[44:47], s71 offen sc1
L_p2b:
    v_lshlrev_b32 v32, 16, v16
    v_and_b32 v33, s6, v16
    v_lshlrev_b32 v34, 16, v17
    v_and_b32 v35, s6, v17
    v_lshlrev_b32 v36, 16, v18
    v_and_b32 v37, s6, v18
    v_lshlrev_b32 v38, 16, v19
    v_and_b32 v39, s6, v19
    v_lshlrev_b32 v40, 16, v20
    v_and_b32 v41, s6, v20
    v_lshlrev_b32 v42, 16, v22
    v_and_b32 v43, s6, v22
    v_lshlrev_b32 v44, 16, v23
    v_and_b32 v45, s6, v23
    v_lshlrev_b32 v46, 16, v24
    v_and_b32 v47, s6, v24
    v_lshlrev_b32 v48, 16, v25
    v_and_b32 v49, s6, v25
    v_lshlrev_b32 v50, 16, v21
    v_and_b32 v51, s6, v21
    v_lshlrev_b32 v208, 16, v28
    v_and_b32 v209, s6, v28
    v_lshlrev_b32 v210, 16, v29
    v_and_b32 v211, s6, v29
    v_lshlrev_b32 v212, 16, v30
    v_and_b32 v213, s6, v30
    v_lshlrev_b32 v214, 16, v31
    v_and_b32 v215, s6, v31
    v_lshlrev_b32 v216, 16, v26
    v_and_b32 v217, s6, v26
    v_pk_add_f32 v[92:93], v[32:33], v[34:35]
    v_pk_add_f32 v[94:95], v[42:43], v[44:45]
    v_pk_add_f32 v[96:97], v[208:209], v[210:211]
    v_pk_add_f32 v[92:93], v[92:93], v[36:37]
    v_pk_add_f32 v[94:95], v[94:95], v[46:47]
    v_pk_add_f32 v[96:97], v[96:97], v[212:213]
    v_pk_add_f32 v[92:93], v[92:93], v[38:39]
    v_pk_add_f32 v[94:95], v[94:95], v[48:49]
    v_pk_add_f32 v[96:97], v[96:97], v[214:215]
    v_pk_add_f32 v[92:93], v[92:93], v[40:41]
    v_pk_add_f32 v[94:95], v[94:95], v[50:51]
    v_pk_add_f32 v[96:97], v[96:97], v[216:217]
    v_add_f32 v2, v92, v93
    v_add_f32 v3, v94, v95
    v_add_f32 v220, v96, v97
    v_add_f32 v218, v96, v97
    v_permlane32_swap_b32 v2, v3
    s_nop 0
    v_permlane32_swap_b32 v220, v218
    v_add_f32 v2, v2, v3
    v_add_f32 v220, v220, v218
    s_nop 0
    v_add_f32_dpp v2, v2, v2 quad_perm:[1,0,3,2] row_mask:0xf bank_mask:0xf
    v_add_f32_dpp v220, v220, v220 quad_perm:[1,0,3,2] row_mask:0xf bank_mask:0xf
    s_nop 0
    v_add_f32_dpp v2, v2, v2 quad_perm:[2,3,0,1] row_mask:0xf bank_mask:0xf
    v_add_f32_dpp v220, v220, v220 quad_perm:[2,3,0,1] row_mask:0xf bank_mask:0xf
    s_nop 0
    v_add_f32_dpp v2, v2, v2 row_half_mirror row_mask:0xf bank_mask:0xf
    v_add_f32_dpp v220, v220, v220 row_half_mirror row_mask:0xf bank_mask:0xf
    s_nop 0
    v_add_f32_dpp v2, v2, v2 row_mirror row_mask:0xf bank_mask:0xf
    v_add_f32_dpp v220, v220, v220 row_mirror row_mask:0xf bank_mask:0xf
    s_nop 0
    v_add_f32_dpp v2, v2, v2 row_bcast:15 row_mask:0xa bank_mask:0xf
    v_add_f32_dpp v220, v220, v220 row_bcast:15 row_mask:0xa bank_mask:0xf
    v_mul_f32 v2, 0.0015625, v2
    v_cvt_pk_bf16_f32 v219, v2, v2
    v_lshlrev_b32 v219, 16, v219
    v_sub_f32 v218, v2, v219
    v_readlane_b32 s78, v219, 16
    v_readlane_b32 s80, v219, 48
    s_nop 0
    v_pk_add_f32 v[72:73], v[32:33], s[78:79] op_sel_hi:[1,0] neg_lo:[0,1] neg_hi:[0,1]
    v_pk_add_f32 v[82:83], v[42:43], s[80:81] op_sel_hi:[1,0] neg_lo:[0,1] neg_hi:[0,1]
    v_pk_add_f32 v[74:75], v[34:35], s[78:79] op_sel_hi:[1,0] neg_lo:[0,1] neg_hi:[0,1]
    v_pk_add_f32 v[84:85], v[44:45], s[80:81] op_sel_hi:[1,0] neg_lo:[0,1] neg_hi:[0,1]
    v_pk_add_f32 v[76:77], v[36:37], s[78:79] op_sel_hi:[1,0] neg_lo:[0,1] neg_hi:[0,1]
    v_pk_add_f32 v[86:87], v[46:47], s[80:81] op_sel_hi:[1,0] neg_lo:[0,1] neg_hi:[0,1]
    v_pk_add_f32 v[78:79], v[38:39], s[78:79] op_sel_hi:[1,0] neg_lo:[0,1] neg_hi:[0,1]
    v_pk_add_f32 v[88:89], v[48:49], s[80:81] op_sel_hi:[1,0] neg_lo:[0,1] neg_hi:[0,1]
    v_pk_add_f32 v[80:81], v[40:41], s[78:79] op_sel_hi:[1,0] neg_lo:[0,1] neg_hi:[0,1]
    v_pk_add_f32 v[90:91], v[50:51], s[80:81] op_sel_hi:[1,0] neg_lo:[0,1] neg_hi:[0,1]
    v_pk_mul_f32 v[92:93], v[72:73], v[72:73]
    v_pk_mul_f32 v[94:95], v[82:83], v[82:83]
    v_pk_fma_f32 v[92:93], v[74:75], v[74:75], v[92:93]
    v_pk_fma_f32 v[94:95], v[84:85], v[84:85], v[94:95]
    v_pk_fma_f32 v[92:93], v[76:77], v[76:77], v[92:93]
    v_pk_fma_f32 v[94:95], v[86:87], v[86:87], v[94:95]
    v_pk_fma_f32 v[92:93], v[78:79], v[78:79], v[92:93]
    v_pk_fma_f32 v[94:95], v[88:89], v[88:89], v[94:95]
    v_pk_fma_f32 v[92:93], v[80:81], v[80:81], v[92:93]
    v_pk_fma_f32 v[94:95], v[90:91], v[90:91], v[94:95]
    v_add_f32 v2, v92, v93
    v_add_f32 v3, v94, v95
    s_nop 1
    v_permlane32_swap_b32 v2, v3
    v_add_f32 v2, v2, v3
    s_nop 1
    v_add_f32_dpp v2, v2, v2 quad_perm:[1,0,3,2] row_mask:0xf bank_mask:0xf
    s_nop 1
    v_add_f32_dpp v2, v2, v2 quad_perm:[2,3,0,1] row_mask:0xf bank_mask:0xf
    s_nop 1
    v_add_f32_dpp v2, v2, v2 row_half_mirror row_mask:0xf bank_mask:0xf
    s_nop 1
    v_add_f32_dpp v2, v2, v2 row_mirror row_mask:0xf bank_mask:0xf
    s_nop 1
    v_add_f32_dpp v2, v2, v2 row_bcast:15 row_mask:0xa bank_mask:0xf
    v_mul_f32 v2, 0.0015625, v2
    v_fma_f32 v2, -v218, v218, v2
    v_cvt_pk_bf16_f32 v2, v2, v2
    v_lshlrev_b32 v2, 16, v2
    v_add_f32 v2, 1e-05, v2
    v_cvt_pk_bf16_f32 v2, v2, v2
    v_lshlrev_b32 v2, 16, v2
    v_sqrt_f32 v2, v2
    s_nop 0
    v_cvt_pk_bf16_f32 v2, v2, v2
    v_lshlrev_b32 v2, 16, v2
    v_rcp_f32 v2, v2
    s_nop 0
    v_readlane_b32 s78, v2, 16
    v_readlane_b32 s80, v2, 48
    s_nop 0
    v_pk_mul_f32 v[52:53], v[72:73], s[78:79] op_sel_hi:[1,0]
    v_pk_mul_f32 v[62:63], v[82:83], s[80:81] op_sel_hi:[1,0]
    v_pk_mul_f32 v[54:55], v[74:75], s[78:79] op_sel_hi:[1,0]
    v_pk_mul_f32 v[64:65], v[84:85], s[80:81] op_sel_hi:[1,0]
    v_pk_mul_f32 v[56:57], v[76:77], s[78:79] op_sel_hi:[1,0]
    v_pk_mul_f32 v[66:67], v[86:87], s[80:81] op_sel_hi:[1,0]
    v_pk_mul_f32 v[58:59], v[78:79], s[78:79] op_sel_hi:[1,0]
    v_pk_mul_f32 v[68:69], v[88:89], s[80:81] op_sel_hi:[1,0]
    v_pk_mul_f32 v[60:61], v[80:81], s[78:79] op_sel_hi:[1,0]
    v_pk_mul_f32 v[70:71], v[90:91], s[80:81] op_sel_hi:[1,0]
    v_lshrrev_b32 v8, 5, v1
    s_lshl_b32 s7, s64, 3
    s_lshl_b32 s69, s3, 1
    s_add_u32 s7, s7, s69
    s_sub_u32 s7, 2047, s7
    s_lshl_b32 s69, s3, 3
    s_add_u32 s69, s69, 131584
    v_lshl_add_u32 v9, v8, 2, s69
    v_sub_u32 v8, s7, v8
    v_mov_b32 v10, 131584
    s_lshl_b32 s93, s64, 7
    s_add_u32 s93, s93, 5259264
    s_cmp_eq_u32 s3, 0
    s_cselect_b32 s93, s93, 8388608
    v_lshrrev_b32 v4, 2, v0
    v_and_b32 v3, 3, v0
    v_lshlrev_b32 v4, 7, v4
    v_lshl_add_u32 v4, v3, 4, v4
    s_mul_i32 s73, s75, 20480
    s_and_b32 s7, s64, 1
    s_lshl_b32 s7, s7, 6
    s_add_u32 s73, s73, s7
    s_add_u32 s73, s73, 2621440
    s_add_u32 s10, s73, 8192
    s_add_u32 s11, s73, 16384
    s_cmp_lt_u32 s3, 2
    s_cselect_b32 s11, s11, 8388608
    v_lshlrev_b32 v5, 2, v0
    v_add_u32 v5, 121344, v5
    s_mul_i32 s7, s3, 2560
    s_add_u32 s7, s7, 121344
    v_lshl_add_u32 v6, v1, 5, s7
    s_add_u32 s7, s7, 2048
    v_lshl_add_u32 v7, v1, 3, s7
    s_mov_b32 s68, 0
    s_cmp_lt_u32 s85, 10
    s_cbranch_scc0 L_nopf
    s_mul_i32 s7, s4, 384
    s_mul_i32 s69, s85, 196608
    s_add_u32 s7, s7, s69
    v_mul_u32_u24 v110, 21846, v0
    v_lshrrev_b32 v110, 16, v110
    v_mul_u32_u24 v111, 3, v110
    v_sub_u32 v111, v0, v111
    v_mul_u32_u24 v110, 3072, v110
    v_lshl_add_u32 v110, v111, 7, v110
    s_cmp_lt_u32 s3, 3
    s_cselect_b32 s7, s7, 0x7f000000
    buffer_load_dword v106, v110, s[48:51], s7 offen
    buffer_load_dword v107, v110, s[56:59], s7 offen
    s_mul_i32 s7, s4, 160
    s_and_b32 s7, s7, 0xffffff80
    s_mul_i32 s69, s85, 66560
    s_add_u32 s7, s7, s69
    s_add_u32 s7, s7, 1310720
    v_lshrrev_b32 v110, 1, v0
    v_and_b32 v111, 1, v0
    v_cmp_gt_u32 vcc, 52, v110
    v_mul_u32_u24 v110, 1280, v110
    v_lshl_add_u32 v110, v111, 7, v110
    v_mov_b32 v111, 0x7f000000
    v_cndmask_b32 v110, v111, v110, vcc
    buffer_load_dword v108, v110, s[88:91], s7 offen
L_nopf:
    s_cmp_lt_u32 s85, 11
    s_cbranch_scc0 L_wld_done
    s_waitcnt vmcnt(0)
    s_mul_i32 s84, s4, 5
    s_add_u32 s84, s84, s85
    s_sub_u32 s84, s84, 6
    s_mul_i32 s97, s3, 20480
    s_mov_b32 m0, s97
    s_cmp_lt_u32 s85, 6
    s_cbranch_scc0 L_prep_down
    v_lshrrev_b32 v2, 2, v1
    v_and_b32 v3, 3, v1
    s_mul_i32 s7, s3, 491520
    s_lshl_b32 s69, s74, 6
    s_add_u32 s7, s7, s69
    v_mul_u32_u24 v221, 3072, v2
    v_lshl_add_u32 v221, v3, 4, v221
    buffer_load_dwordx4 v221, s[48:51], s7 offen lds
    s_add_u32 m0, m0, 1024
    s_add_u32 s7, s7, 49152
    buffer_load_dwordx4 v221, s[48:51], s7 offen lds
    s_add_u32 m0, m0, 1024
    s_add_u32 s7, s7, 49152
    buffer_load_dwordx4 v221, s[48:51], s7 offen lds
    s_add_u32 m0, m0, 1024
    s_add_u32 s7, s7, 49152
    buffer_load_dwordx4 v221, s[48:51], s7 offen lds
    s_add_u32 m0, m0, 1024
    s_add_u32 s7, s7, 49152
    buffer_load_dwordx4 v221, s[48:51], s7 offen lds
    s_add_u32 m0, m0, 1024
    s_add_u32 s7, s7, 49152
    buffer_load_dwordx4 v221, s[48:51], s7 offen lds
    s_add_u32 m0, m0, 1024
    s_add_u32 s7, s7, 49152
    buffer_load_dwordx4 v221, s[48:51], s7 offen lds
    s_add_u32 m0, m0, 1024
    s_add_u32 s7, s7, 49152
    buffer_load_dwordx4 v221, s[48:51], s7 offen lds
    s_add_u32 m0, m0, 1024
    s_add_u32 s7, s7, 49152
    buffer_load_dwordx4 v221, s[48:51], s7 offen lds
    s_add_u32 m0, m0, 1024
    s_add_u32 s7, s7, 49152
    buffer_load_dwordx4 v221, s[48:51], s7 offen lds
    s_add_u32 m0, m0, 1024
    s_sub_u32 s7, s7, 442368
    buffer_load_dwordx4 v221, s[56:59], s7 offen lds
    s_add_u32 m0, m0, 1024
    s_add_u32 s7, s7, 49152
    buffer_load_dwordx4 v221, s[56:59], s7 offen lds
    s_add_u32 m0, m0, 1024
    s_add_u32 s7, s7, 49152
    buffer_load_dword v12, v14, s[44:47], s71 offen sc1
    buffer_load_dwordx4 v221, s[56:59], s7 offen lds
    s_add_u32 m0, m0, 1024
    s_add_u32 s7, s7, 49152
    buffer_load_dwordx4 v221, s[56:59], s7 offen lds
    s_add_u32 m0, m0, 1024
    s_add_u32 s7, s7, 49152
    buffer_load_dwordx4 v221, s[56:59], s7 offen lds
    s_add_u32 m0, m0, 1024
    s_add_u32 s7, s7, 49152
    buffer_load_dwordx4 v221, s[56:59], s7 offen lds
    s_add_u32 m0, m0, 1024
    s_add_u32 s7, s7, 49152
    buffer_load_dwordx4 v221, s[56:59], s7 offen lds
    s_add_u32 m0, m0, 1024
    s_add_u32 s7, s7, 49152
    buffer_load_dwordx4 v221, s[56:59], s7 offen lds
    s_add_u32 m0, m0, 1024
    s_add_u32 s7, s7, 49152
    buffer_load_dwordx4 v221, s[56:59], s7 offen lds
    s_add_u32 m0, m0, 1024
    s_add_u32 s7, s7, 49152
    buffer_load_dwordx4 v221, s[56:59], s7 offen lds
    v_lshrrev_b32 v2, 4, v1
    v_bfe_u32 v3, v1, 2, 2
    v_lshlrev_b32 v222, 9, v2
    v_lshl_add_u32 v222, v3, 6, v222
    v_and_b32 v3, 3, v1
    v_lshl_add_u32 v222, v3, 3, v222
    v_add_u32 v222, s97, v222
    s_branch L_wld_done
L_prep_down:
    v_lshrrev_b32 v2, 1, v1
    v_and_b32 v3, 1, v1
    s_mul_i32 s7, s3, 491520
    s_lshl_b32 s69, s84, 5
    s_add_u32 s7, s7, s69
    v_mul_u32_u24 v221, 1280, v2
    v_lshl_add_u32 v221, v3, 4, v221
    buffer_load_dwordx4 v221, s[88:91], s7 offen lds
    s_add_u32 m0, m0, 1024
    s_add_u32 s7, s7, 40960
    buffer_load_dwordx4 v221, s[88:91], s7 offen lds
    s_add_u32 m0, m0, 1024
    s_add_u32 s7, s7, 40960
    buffer_load_dwordx4 v221, s[88:91], s7 offen lds
    s_add_u32 m0, m0, 1024
    s_add_u32 s7, s7, 40960
    buffer_load_dwordx4 v221, s[88:91], s7 offen lds
    s_add_u32 m0, m0, 1024
    s_add_u32 s7, s7, 40960
    buffer_load_dword v12, v14, s[44:47], s71 offen sc1
    buffer_load_dwordx4 v221, s[88:91], s7 offen lds
    s_add_u32 m0, m0, 1024
    s_add_u32 s7, s7, 40960
    buffer_load_dwordx4 v221, s[88:91], s7 offen lds
    s_add_u32 m0, m0, 1024
    s_add_u32 s7, s7, 40960
    buffer_load_dwordx4 v221, s[88:91], s7 offen lds
    s_add_u32 m0, m0, 1024
    s_add_u32 s7, s7, 40960
    buffer_load_dwordx4 v221, s[88:91], s7 offen lds
    s_add_u32 m0, m0, 1024
    s_add_u32 s7, s7, 40960
    buffer_load_dwordx4 v221, s[88:91], s7 offen lds
    s_add_u32 m0, m0, 1024
    s_add_u32 s7, s7, 40960
    buffer_load_dwordx4 v221, s[88:91], s7 offen lds
    s_add_u32 m0, m0, 1024
    s_add_u32 s7, s7, 40960
    buffer_load_dwordx4 v221, s[88:91], s7 offen lds
    s_add_u32 m0, m0, 1024
    s_add_u32 s7, s7, 40960
    buffer_load_dwordx4 v221, s[88:91], s7 offen lds
    v_lshrrev_b32 v2, 4, v1
    v_bfe_u32 v3, v1, 2, 2
    v_lshlrev_b32 v222, 8, v2
    v_lshl_add_u32 v222, v3, 5, v222
    v_and_b32 v3, 3, v1
    v_lshl_add_u32 v222, v3, 3, v222
    v_add_u32 v222, s97, v222
L_wld_done:
    s_cmp_lt_u32 s85, 11
    s_cbranch_scc0 L_f1w0
    s_waitcnt vmcnt(8)
    s_branch L_f1w1
L_f1w0:
    s_waitcnt vmcnt(0)
L_f1w1:
    v_cmp_ne_u32 vcc, s92, v12
    s_cbranch_vccz L_b1x
L_b1:
    s_sleep 4
    s_mov_b64 exec, vcc
    buffer_load_dword v12, v14, s[44:47], s71 offen sc1
    s_add_u32 s68, s68, 1
    s_cmp_gt_u32 s68, 400000
    s_cbranch_scc1 L_b1x
    s_waitcnt vmcnt(0)
    v_cmp_ne_u32 vcc, s92, v12
    s_cbranch_vccnz L_b1
L_b1x:
    s_mov_b64 exec, -1
    s_barrier
L_ypoll:
    buffer_load_dwordx4 v[100:103], v4, s[44:47], s73 offen sc1
    buffer_load_dwordx4 v[104:107], v4, s[44:47], s10 offen sc1
    buffer_load_dwordx4 v[108:111], v4, s[44:47], s11 offen sc1
    s_add_u32 s68, s68, 1
    s_cmp_gt_u32 s68, 400000
    s_cbranch_scc1 L_ypollx
    s_waitcnt vmcnt(2)
    v_max3_u32 v2, v100, v101, v102
    s_waitcnt vmcnt(1)
    v_max3_u32 v2, v2, v103, v104
    v_max3_u32 v2, v2, v105, v106
    s_waitcnt vmcnt(0)
    v_max3_u32 v2, v2, v107, v108
    v_max3_u32 v2, v2, v109, v110
    v_max_u32 v2, v2, v111
    v_cmp_eq_u32 vcc, -1, v2
    s_cbranch_vccnz L_yretry
L_ypollx:
    s_mov_b64 exec, -1
    s_waitcnt vmcnt(0)
    ds_write2st64_b32 v5, v100, v101 offset0:0 offset1:10
    ds_write2st64_b32 v5, v102, v103 offset0:20 offset1:30
    ds_write2st64_b32 v5, v104, v105 offset0:4 offset1:14
    ds_write2st64_b32 v5, v106, v107 offset0:24 offset1:34
    s_cmp_lt_u32 s3, 2
    s_cbranch_scc0 L_pw2
    ds_write2st64_b32 v5, v108, v109 offset0:8 offset1:18
    ds_write2st64_b32 v5, v110, v111 offset0:28 offset1:38
L_pw2:
    s_waitcnt lgkmcnt(0)
    s_barrier
    ds_read_b128 v[100:103], v6
    ds_read_b128 v[104:107], v6 offset:16
    ds_read_b64 v[108:109], v7
    s_waitcnt lgkmcnt(2)
    v_lshlrev_b32 v110, 16, v100
    v_and_b32 v120, s6, v100
    v_lshlrev_b32 v111, 16, v101
    v_and_b32 v121, s6, v101
    v_pk_fma_f32 v[130:131], v[52:53], v[110:111], v[72:73]
    v_pk_fma_f32 v[140:141], v[62:63], v[120:121], v[82:83]
    v_pk_mul_f32 v[96:97], v[130:131], v[130:131]
    v_pk_mul_f32 v[244:245], v[130:131], v[208:209]
    v_pk_mul_f32 v[98:99], v[140:141], v[140:141]
    v_pk_mul_f32 v[246:247], v[140:141], v[208:209]
    v_lshlrev_b32 v112, 16, v102
    v_and_b32 v122, s6, v102
    v_lshlrev_b32 v113, 16, v103
    v_and_b32 v123, s6, v103
    v_pk_fma_f32 v[132:133], v[54:55], v[112:113], v[74:75]
    v_pk_fma_f32 v[142:143], v[64:65], v[122:123], v[84:85]
    v_pk_add_f32 v[92:93], v[130:131], v[132:133]
    v_pk_fma_f32 v[96:97], v[132:133], v[132:133], v[96:97]
    v_pk_fma_f32 v[244:245], v[132:133], v[210:211], v[244:245]
    v_pk_add_f32 v[94:95], v[140:141], v[142:143]
    v_pk_fma_f32 v[98:99], v[142:143], v[142:143], v[98:99]
    v_pk_fma_f32 v[246:247], v[142:143], v[210:211], v[246:247]
    s_waitcnt lgkmcnt(1)
    v_lshlrev_b32 v114, 16, v104
    v_and_b32 v124, s6, v104
    v_lshlrev_b32 v115, 16, v105
    v_and_b32 v125, s6, v105
    v_pk_fma_f32 v[134:135], v[56:57], v[114:115], v[76:77]
    v_pk_fma_f32 v[144:145], v[66:67], v[124:125], v[86:87]
    v_pk_add_f32 v[92:93], v[92:93], v[134:135]
    v_pk_fma_f32 v[96:97], v[134:135], v[134:135], v[96:97]
    v_pk_fma_f32 v[244:245], v[134:135], v[212:213], v[244:245]
    v_pk_add_f32 v[94:95], v[94:95], v[144:145]
    v_pk_fma_f32 v[98:99], v[144:145], v[144:145], v[98:99]
    v_pk_fma_f32 v[246:247], v[144:145], v[212:213], v[246:247]
    v_lshlrev_b32 v116, 16, v106
    v_and_b32 v126, s6, v106
    v_lshlrev_b32 v117, 16, v107
    v_and_b32 v127, s6, v107
    v_pk_fma_f32 v[136:137], v[58:59], v[116:117], v[78:79]
    v_pk_fma_f32 v[146:147], v[68:69], v[126:127], v[88:89]
    v_pk_add_f32 v[92:93], v[92:93], v[136:137]
    v_pk_fma_f32 v[96:97], v[136:137], v[136:137], v[96:97]
    v_pk_fma_f32 v[244:245], v[136:137], v[214:215], v[244:245]
    v_pk_add_f32 v[94:95], v[94:95], v[146:147]
    v_pk_fma_f32 v[98:99], v[146:147], v[146:147], v[98:99]
    v_pk_fma_f32 v[246:247], v[146:147], v[214:215], v[246:247]
    s_waitcnt lgkmcnt(0)
    v_lshlrev_b32 v118, 16, v108
    v_and_b32 v128, s6, v108
    v_lshlrev_b32 v119, 16, v109
    v_and_b32 v129, s6, v109
    v_pk_fma_f32 v[138:139], v[60:61], v[118:119], v[80:81]
    v_pk_fma_f32 v[148:149], v[70:71], v[128:129], v[90:91]
    v_pk_add_f32 v[92:93], v[92:93], v[138:139]
    v_pk_fma_f32 v[96:97], v[138:139], v[138:139], v[96:97]
    v_pk_fma_f32 v[244:245], v[138:139], v[216:217], v[244:245]
    v_pk_add_f32 v[94:95], v[94:95], v[148:149]
    v_pk_fma_f32 v[98:99], v[148:149], v[148:149], v[98:99]
    v_pk_fma_f32 v[246:247], v[148:149], v[216:217], v[246:247]
    v_add_f32 v2, v92, v93
    v_add_f32 v3, v94, v95
    v_add_f32 v248, v96, v97
    v_add_f32 v250, v98, v99
    v_add_f32 v249, v244, v245
    v_add_f32 v251, v246, v247
    v_permlane32_swap_b32 v2, v3
    v_permlane32_swap_b32 v248, v250
    v_permlane32_swap_b32 v249, v251
    v_add_f32 v2, v2, v3
    v_add_f32 v248, v248, v250
    v_add_f32 v249, v249, v251
    v_add_f32_dpp v2, v2, v2 quad_perm:[1,0,3,2] row_mask:0xf bank_mask:0xf
    v_add_f32_dpp v248, v248, v248 quad_perm:[1,0,3,2] row_mask:0xf bank_mask:0xf
    v_add_f32_dpp v249, v249, v249 quad_perm:[1,0,3,2] row_mask:0xf bank_mask:0xf
    v_add_f32_dpp v2, v2, v2 quad_perm:[2,3,0,1] row_mask:0xf bank_mask:0xf
    v_add_f32_dpp v248, v248, v248 quad_perm:[2,3,0,1] row_mask:0xf bank_mask:0xf
    v_add_f32_dpp v249, v249, v249 quad_perm:[2,3,0,1] row_mask:0xf bank_mask:0xf
    v_add_f32_dpp v2, v2, v2 row_half_mirror row_mask:0xf bank_mask:0xf
    v_add_f32_dpp v248, v248, v248 row_half_mirror row_mask:0xf bank_mask:0xf
    v_add_f32_dpp v249, v249, v249 row_half_mirror row_mask:0xf bank_mask:0xf
    v_add_f32_dpp v2, v2, v2 row_mirror row_mask:0xf bank_mask:0xf
    v_add_f32_dpp v248, v248, v248 row_mirror row_mask:0xf bank_mask:0xf
    v_add_f32_dpp v249, v249, v249 row_mirror row_mask:0xf bank_mask:0xf
    v_add_f32_dpp v2, v2, v2 row_bcast:15 row_mask:0xa bank_mask:0xf
    v_add_f32_dpp v248, v248, v248 row_bcast:15 row_mask:0xa bank_mask:0xf
    v_add_f32_dpp v249, v249, v249 row_bcast:15 row_mask:0xa bank_mask:0xf
    v_mul_f32 v2, 0.0015625, v2
    v_mul_f32 v248, 0.0015625, v248
    v_add_f32 v250, v2, v219
    v_fma_f32 v248, -v2, v2, v248
    v_max_f32 v248, 0, v248
    v_cvt_pk_bf16_f32 v248, v248, v248
    v_lshlrev_b32 v248, 16, v248
    v_add_f32 v248, 1e-05, v248
    v_cvt_pk_bf16_f32 v248, v248, v248
    v_lshlrev_b32 v248, 16, v248
    v_sqrt_f32 v248, v248
    v_cvt_pk_bf16_f32 v251, v250, v250
    v_cvt_pk_bf16_f32 v248, v248, v248
    v_lshlrev_b32 v248, 16, v248
    v_rcp_f32 v248, v248
    v_lshlrev_b32 v251, 16, v251
    v_sub_f32 v250, v251, v219
    v_fma_f32 v249, -v250, v220, v249
    v_mul_f32 v2, v249, v248
    v_cvt_pk_bf16_f32 v2, v2, v2
    v_ashrrev_i32 v3, 31, v2
    v_or_b32 v3, 0x80000000, v3
    v_xor_b32 v2, v2, v3
    v_and_or_b32 v2, v2, s6, v8
    s_mov_b32 exec_lo, 0x10000
    s_mov_b32 exec_hi, 0x10000
    ds_write_b32 v9, v2
    s_mov_b64 exec, -1
    v_readlane_b32 s78, v251, 16
    v_readlane_b32 s80, v251, 48
    v_readlane_b32 s94, v248, 16
    v_readlane_b32 s96, v248, 48
    s_waitcnt lgkmcnt(0)
    s_barrier
    ds_read_b128 v[174:177], v10
    ds_read_b128 v[178:181], v10 offset:16
    v_pk_fma_f32 v[110:111], v[52:53], v[110:111], v[32:33]
    v_cvt_pk_bf16_f32 v150, v110, v111
    v_lshlrev_b32 v130, 16, v150
    v_and_b32 v131, s6, v150
    v_pk_add_f32 v[224:225], v[130:131], s[78:79] op_sel_hi:[1,0] neg_lo:[0,1] neg_hi:[0,1]
    v_pk_mul_f32 v[224:225], v[224:225], s[94:95] op_sel_hi:[1,0]
    v_cvt_pk_bf16_f32 v162, v224, v225
    v_pk_fma_f32 v[120:121], v[62:63], v[120:121], v[42:43]
    s_waitcnt lgkmcnt(1)
    v_max_u32 v182, v174, v175
    v_min_u32 v183, v174, v175
    v_med3_u32 v183, v182, v183, v176
    v_max_u32 v182, v182, v176
    v_med3_u32 v183, v182, v183, v177
    v_max_u32 v182, v182, v177
    s_waitcnt lgkmcnt(0)
    v_med3_u32 v183, v182, v183, v178
    v_max_u32 v182, v182, v178
    v_med3_u32 v183, v182, v183, v179
    v_max_u32 v182, v182, v179
    v_med3_u32 v183, v182, v183, v180
    v_max_u32 v182, v182, v180
    v_med3_u32 v183, v182, v183, v181
    v_max_u32 v182, v182, v181
    s_mov_b64 exec, 1
    buffer_store_dwordx2 v[182:183], off, s[44:47], s93 sc1
    s_mov_b64 exec, -1
    v_readfirstlane_b32 s82, v182
    v_readfirstlane_b32 s83, v183
    v_cvt_pk_bf16_f32 v156, v120, v121
    v_lshlrev_b32 v140, 16, v156
    v_and_b32 v141, s6, v156
    v_pk_add_f32 v[234:235], v[140:141], s[80:81] op_sel_hi:[1,0] neg_lo:[0,1] neg_hi:[0,1]
    v_pk_mul_f32 v[234:235], v[234:235], s[96:97] op_sel_hi:[1,0]
    v_cvt_pk_bf16_f32 v168, v234, v235
    v_pk_fma_f32 v[112:113], v[54:55], v[112:113], v[34:35]
    v_cvt_pk_bf16_f32 v151, v112, v113
    v_lshlrev_b32 v132, 16, v151
    v_and_b32 v133, s6, v151
    v_pk_add_f32 v[226:227], v[132:133], s[78:79] op_sel_hi:[1,0] neg_lo:[0,1] neg_hi:[0,1]
    v_pk_mul_f32 v[226:227], v[226:227], s[94:95] op_sel_hi:[1,0]
    v_cvt_pk_bf16_f32 v163, v226, v227
    v_pk_fma_f32 v[122:123], v[64:65], v[122:123], v[44:45]
    v_cvt_pk_bf16_f32 v157, v122, v123
    v_lshlrev_b32 v142, 16, v157
    v_and_b32 v143, s6, v157
    v_pk_add_f32 v[236:237], v[142:143], s[80:81] op_sel_hi:[1,0] neg_lo:[0,1] neg_hi:[0,1]
    v_pk_mul_f32 v[236:237], v[236:237], s[96:97] op_sel_hi:[1,0]
    v_cvt_pk_bf16_f32 v169, v236, v237
    v_pk_fma_f32 v[114:115], v[56:57], v[114:115], v[36:37]
    v_cvt_pk_bf16_f32 v152, v114, v115
    v_lshlrev_b32 v134, 16, v152
    v_and_b32 v135, s6, v152
    v_pk_add_f32 v[228:229], v[134:135], s[78:79] op_sel_hi:[1,0] neg_lo:[0,1] neg_hi:[0,1]
    v_pk_mul_f32 v[228:229], v[228:229], s[94:95] op_sel_hi:[1,0]
    v_cvt_pk_bf16_f32 v164, v228, v229
    v_pk_fma_f32 v[124:125], v[66:67], v[124:125], v[46:47]
    v_cvt_pk_bf16_f32 v158, v124, v125
    v_lshlrev_b32 v144, 16, v158
    v_and_b32 v145, s6, v158
    v_pk_add_f32 v[238:239], v[144:145], s[80:81] op_sel_hi:[1,0] neg_lo:[0,1] neg_hi:[0,1]
    v_pk_mul_f32 v[238:239], v[238:239], s[96:97] op_sel_hi:[1,0]
    v_cvt_pk_bf16_f32 v170, v238, v239
    v_pk_fma_f32 v[116:117], v[58:59], v[116:117], v[38:39]
    v_cvt_pk_bf16_f32 v153, v116, v117
    v_lshlrev_b32 v136, 16, v153
    v_and_b32 v137, s6, v153
    v_pk_add_f32 v[230:231], v[136:137], s[78:79] op_sel_hi:[1,0] neg_lo:[0,1] neg_hi:[0,1]
    v_pk_mul_f32 v[230:231], v[230:231], s[94:95] op_sel_hi:[1,0]
    v_cvt_pk_bf16_f32 v165, v230, v231
    v_pk_fma_f32 v[126:127], v[68:69], v[126:127], v[48:49]
    v_cvt_pk_bf16_f32 v159, v126, v127
    v_lshlrev_b32 v146, 16, v159
    v_and_b32 v147, s6, v159
    v_pk_add_f32 v[240:241], v[146:147], s[80:81] op_sel_hi:[1,0] neg_lo:[0,1] neg_hi:[0,1]
    v_pk_mul_f32 v[240:241], v[240:241], s[96:97] op_sel_hi:[1,0]
    v_cvt_pk_bf16_f32 v171, v240, v241
    v_pk_fma_f32 v[118:119], v[60:61], v[118:119], v[40:41]
    v_cvt_pk_bf16_f32 v154, v118, v119
    v_lshlrev_b32 v138, 16, v154
    v_and_b32 v139, s6, v154
    v_pk_add_f32 v[232:233], v[138:139], s[78:79] op_sel_hi:[1,0] neg_lo:[0,1] neg_hi:[0,1]
    v_pk_mul_f32 v[232:233], v[232:233], s[94:95] op_sel_hi:[1,0]
    v_cvt_pk_bf16_f32 v166, v232, v233
    v_pk_fma_f32 v[128:129], v[70:71], v[128:129], v[50:51]
    v_cvt_pk_bf16_f32 v160, v128, v129
    v_lshlrev_b32 v148, 16, v160
    v_and_b32 v149, s6, v160
    v_pk_add_f32 v[242:243], v[148:149], s[80:81] op_sel_hi:[1,0] neg_lo:[0,1] neg_hi:[0,1]
    v_pk_mul_f32 v[242:243], v[242:243], s[96:97] op_sel_hi:[1,0]
    v_cvt_pk_bf16_f32 v172, v242, v243
    v_lshlrev_b32 v4, 4, v1
    v_lshlrev_b32 v5, 2, v1
    v_add_u32 v5, 1024, v5
    s_not_b32 s7, s82
    s_bfe_u32 s69, s7, 0x20001
    s_cmp_eq_u32 s69, s3
    s_cbranch_scc0 L_pl0
    s_bitcmp1_b32 s7, 0
    s_cselect_b64 s[76:77], -1, 0
    s_mul_i32 s70, s64, 2560
    s_add_u32 s70, s70, 5308416
    v_cndmask_b32 v184, v162, v168, s[76:77]
    v_cndmask_b32 v185, v163, v169, s[76:77]
    v_cndmask_b32 v186, v164, v170, s[76:77]
    v_cndmask_b32 v187, v165, v171, s[76:77]
    v_cndmask_b32 v188, v166, v172, s[76:77]
    buffer_store_dwordx4 v[184:187], v4, s[44:47], s70 offen sc1
    buffer_store_dword v188, v5, s[44:47], s70 offen sc1
L_pl0:
    s_not_b32 s7, s83
    s_bfe_u32 s69, s7, 0x20001
    s_cmp_eq_u32 s69, s3
    s_cbranch_scc0 L_pl1
    s_bitcmp1_b32 s7, 0
    s_cselect_b64 s[76:77], -1, 0
    s_mul_i32 s70, s64, 2560
    s_add_u32 s70, s70, 5309696
    v_cndmask_b32 v190, v162, v168, s[76:77]
    v_cndmask_b32 v191, v163, v169, s[76:77]
    v_cndmask_b32 v192, v164, v170, s[76:77]
    v_cndmask_b32 v193, v165, v171, s[76:77]
    v_cndmask_b32 v194, v166, v172, s[76:77]
    buffer_store_dwordx4 v[190:193], v4, s[44:47], s70 offen sc1
    buffer_store_dword v194, v5, s[44:47], s70 offen sc1
L_pl1:
    v_lshlrev_b32 v224, 16, v162
    v_and_b32 v225, s6, v162
    v_pk_add_f32 v[224:225], v[224:225], v[130:131]
    v_cvt_pk_bf16_f32 v196, v224, v225
    v_lshlrev_b32 v234, 16, v168
    v_and_b32 v235, s6, v168
    v_pk_add_f32 v[234:235], v[234:235], v[140:141]
    v_cvt_pk_bf16_f32 v202, v234, v235
    v_lshlrev_b32 v226, 16, v163
    v_and_b32 v227, s6, v163
    v_pk_add_f32 v[226:227], v[226:227], v[132:133]
    v_cvt_pk_bf16_f32 v197, v226, v227
    v_lshlrev_b32 v236, 16, v169
    v_and_b32 v237, s6, v169
    v_pk_add_f32 v[236:237], v[236:237], v[142:143]
    v_cvt_pk_bf16_f32 v203, v236, v237
    v_lshlrev_b32 v228, 16, v164
    v_and_b32 v229, s6, v164
    v_pk_add_f32 v[228:229], v[228:229], v[134:135]
    v_cvt_pk_bf16_f32 v198, v228, v229
    v_lshlrev_b32 v238, 16, v170
    v_and_b32 v239, s6, v170
    v_pk_add_f32 v[238:239], v[238:239], v[144:145]
    v_cvt_pk_bf16_f32 v204, v238, v239
    v_lshlrev_b32 v230, 16, v165
    v_and_b32 v231, s6, v165
    v_pk_add_f32 v[230:231], v[230:231], v[136:137]
    v_cvt_pk_bf16_f32 v199, v230, v231
    v_lshlrev_b32 v240, 16, v171
    v_and_b32 v241, s6, v171
    v_pk_add_f32 v[240:241], v[240:241], v[146:147]
    v_cvt_pk_bf16_f32 v205, v240, v241
    v_lshlrev_b32 v232, 16, v166
    v_and_b32 v233, s6, v166
    v_pk_add_f32 v[232:233], v[232:233], v[138:139]
    v_cvt_pk_bf16_f32 v200, v232, v233
    v_lshlrev_b32 v242, 16, v172
    v_and_b32 v243, s6, v172
    v_pk_add_f32 v[242:243], v[242:243], v[148:149]
    v_cvt_pk_bf16_f32 v206, v242, v243
    buffer_store_dwordx4 v[196:199], v27, s[52:55], 0 offen offset:0 sc1
    buffer_store_dword v200, v13, s[52:55], 0 offen offset:0 sc1
    buffer_store_dwordx4 v[202:205], v27, s[52:55], 0 offen offset:1280 sc1
    buffer_store_dword v206, v13, s[52:55], 0 offen offset:1280 sc1
    s_not_b32 s7, s82
    s_bfe_u32 s69, s7, 0x20001
    s_cmp_eq_u32 s69, s3
    s_cbranch_scc0 L_ph0
    s_bitcmp1_b32 s7, 0
    s_cselect_b64 s[76:77], -1, 0
    s_mul_i32 s70, s64, 2560
    s_add_u32 s70, s70, 5963776
    v_cndmask_b32 v184, v150, v156, s[76:77]
    v_cndmask_b32 v185, v151, v157, s[76:77]
    v_cndmask_b32 v186, v152, v158, s[76:77]
    v_cndmask_b32 v187, v153, v159, s[76:77]
    v_cndmask_b32 v188, v154, v160, s[76:77]
    buffer_store_dwordx4 v[184:187], v4, s[44:47], s70 offen sc1
    buffer_store_dword v188, v5, s[44:47], s70 offen sc1
L_ph0:
    s_not_b32 s7, s83
    s_bfe_u32 s69, s7, 0x20001
    s_cmp_eq_u32 s69, s3
    s_cbranch_scc0 L_ph1
    s_bitcmp1_b32 s7, 0
    s_cselect_b64 s[76:77], -1, 0
    s_mul_i32 s70, s64, 2560
    s_add_u32 s70, s70, 5965056
    v_cndmask_b32 v190, v150, v156, s[76:77]
    v_cndmask_b32 v191, v151, v157, s[76:77]
    v_cndmask_b32 v192, v152, v158, s[76:77]
    v_cndmask_b32 v193, v153, v159, s[76:77]
    v_cndmask_b32 v194, v154, v160, s[76:77]
    buffer_store_dwordx4 v[190:193], v4, s[44:47], s70 offen sc1
    buffer_store_dword v194, v5, s[44:47], s70 offen sc1
L_ph1:
    s_cmp_lt_u32 s85, 11
    s_cbranch_scc1 L_role
    s_waitcnt vmcnt(0)
    s_barrier
    s_lshl_b32 s7, s64, 7
    s_add_u32 s7, s7, 6684672
    s_cmp_eq_u32 s3, 0
    s_cselect_b32 s7, s7, 8388608
    v_mov_b32 v2, 1
    s_mov_b64 exec, 1
    buffer_store_dword v2, off, s[44:47], s7 sc1
    s_mov_b64 exec, -1
    s_branch L_fin
L_role:
    v_lshrrev_b32 v5, 4, v0
    v_lshlrev_b32 v5, 3, v5
    v_add_u32 v5, 131648, v5
    v_and_b32 v2, 15, v1
    v_lshlrev_b32 v6, 3, v2
    v_add_u32 v6, 131648, v6
    v_lshrrev_b32 v3, 4, v1
    v_lshlrev_b32 v86, 7, v2
    v_lshl_add_u32 v86, v3, 4, v86
    s_lshl_b32 s7, s3, 9
    s_add_u32 s7, s7, 121344
    v_add_u32 v86, s7, v86
    v_lshlrev_b32 v87, 2, v1
    v_add_u32 v94, 132864, v87
    v_add_u32 v87, 121344, v87
    v_lshlrev_b32 v93, 6, v2
    v_lshl_add_u32 v93, v3, 4, v93
    s_lshl_b32 s7, s3, 7
    s_add_u32 s7, s7, 132864
    v_add_u32 v93, s7, v93
    s_mul_i32 s7, s3, 640
    s_add_u32 s7, s7, 103936
    v_lshl_add_u32 v84, v1, 4, s7
    v_and_b32 v2, 1, v1
    v_mul_u32_u24 v2, 320, v2
    v_lshl_add_u32 v2, v3, 4, v2
    v_add_u32 v85, s7, v2
    v_mul_u32_u24 v4, 2560, v1
    s_mov_b32 s7, 5272832
    s_mov_b32 s68, 0
    s_mov_b64 exec, 255
L_gtrig:
    buffer_load_dword v2, v4, s[44:47], s7 offen sc1
    s_add_u32 s68, s68, 1
    s_cmp_gt_u32 s68, 400000
    s_waitcnt vmcnt(0)
    v_cmp_ne_u32 vcc, -1, v2
    s_cbranch_scc1 L_gtrigx
    s_bcnt1_i32_b64 s69, vcc
    s_cmp_lt_u32 s69, 2
    s_cbranch_scc1 L_gtrig
L_gtrigx:
    s_mov_b64 exec, -1
    v_lshlrev_b32 v4, 7, v0
    s_mov_b32 s7, 5259264
    s_mov_b32 s68, 0
L_gpoll:
    buffer_load_dwordx2 v[244:245], v4, s[44:47], s7 offen sc1
    s_add_u32 s68, s68, 1
    s_cmp_gt_u32 s68, 400000
    s_waitcnt vmcnt(0)
    s_cbranch_scc1 L_gpollx
L_gfirst:
    v_max_u32 v2, v244, v245
    v_cmp_eq_u32 vcc, -1, v2
    s_and_b64 exec, exec, vcc
    s_cbranch_execnz L_gpoll
L_gpollx:
    s_mov_b64 exec, -1
    v_min_u32_dpp v246, v244, v244 quad_perm:[1,0,3,2] row_mask:0xf bank_mask:0xf
    v_max_u32_dpp v247, v245, v245 quad_perm:[1,0,3,2] row_mask:0xf bank_mask:0xf
    v_max_u32_dpp v244, v244, v244 quad_perm:[1,0,3,2] row_mask:0xf bank_mask:0xf
    v_max_u32 v245, v246, v247
    s_nop 0
    v_min_u32_dpp v246, v244, v244 quad_perm:[2,3,0,1] row_mask:0xf bank_mask:0xf
    v_max_u32_dpp v247, v245, v245 quad_perm:[2,3,0,1] row_mask:0xf bank_mask:0xf
    v_max_u32_dpp v244, v244, v244 quad_perm:[2,3,0,1] row_mask:0xf bank_mask:0xf
    v_max_u32 v245, v246, v247
    s_nop 0
    v_min_u32_dpp v246, v244, v244 row_half_mirror row_mask:0xf bank_mask:0xf
    v_max_u32_dpp v247, v245, v245 row_half_mirror row_mask:0xf bank_mask:0xf
    v_max_u32_dpp v244, v244, v244 row_half_mirror row_mask:0xf bank_mask:0xf
    v_max_u32 v245, v246, v247
    s_nop 0
    v_min_u32_dpp v246, v244, v244 row_mirror row_mask:0xf bank_mask:0xf
    v_max_u32_dpp v247, v245, v245 row_mirror row_mask:0xf bank_mask:0xf
    v_max_u32_dpp v244, v244, v244 row_mirror row_mask:0xf bank_mask:0xf
    v_max_u32 v245, v246, v247
    ds_write_b64 v5, v[244:245]
    s_waitcnt lgkmcnt(0)
    s_barrier
    ds_read_b64 v[244:245], v6
    s_waitcnt lgkmcnt(0)
    v_min_u32_dpp v246, v244, v244 quad_perm:[1,0,3,2] row_mask:0xf bank_mask:0xf
    v_max_u32_dpp v247, v245, v245 quad_perm:[1,0,3,2] row_mask:0xf bank_mask:0xf
    v_max_u32_dpp v244, v244, v244 quad_perm:[1,0,3,2] row_mask:0xf bank_mask:0xf
    v_max_u32 v245, v246, v247
    s_nop 0
    v_min_u32_dpp v246, v244, v244 quad_perm:[2,3,0,1] row_mask:0xf bank_mask:0xf
    v_max_u32_dpp v247, v245, v245 quad_perm:[2,3,0,1] row_mask:0xf bank_mask:0xf
    v_max_u32_dpp v244, v244, v244 quad_perm:[2,3,0,1] row_mask:0xf bank_mask:0xf
    v_max_u32 v245, v246, v247
    s_nop 0
    v_min_u32_dpp v246, v244, v244 row_half_mirror row_mask:0xf bank_mask:0xf
    v_max_u32_dpp v247, v245, v245 row_half_mirror row_mask:0xf bank_mask:0xf
    v_max_u32_dpp v244, v244, v244 row_half_mirror row_mask:0xf bank_mask:0xf
    v_max_u32 v245, v246, v247
    s_nop 0
    v_min_u32_dpp v246, v244, v244 row_mirror row_mask:0xf bank_mask:0xf
    v_max_u32_dpp v247, v245, v245 row_mirror row_mask:0xf bank_mask:0xf
    v_max_u32_dpp v244, v244, v244 row_mirror row_mask:0xf bank_mask:0xf
    v_max_u32 v245, v246, v247
    v_readfirstlane_b32 s82, v244
    v_readfirstlane_b32 s83, v245
    s_not_b32 s78, s82
    s_and_b32 s78, s78, 0x7ff
    s_not_b32 s79, s83
    s_and_b32 s79, s79, 0x7ff
    s_lshr_b32 s7, s78, 3
    s_lshr_b32 s69, s79, 3
    s_mul_i32 s80, s7, 2560
    s_mul_i32 s81, s69, 2560
    s_cmp_eq_u32 s7, s69
    s_cselect_b32 s70, 1280, 0
    s_add_u32 s81, s81, s70
    s_cmp_lt_u32 s85, 6
    s_cbranch_scc0 L_down
    v_cmp_lt_u32 vcc, 19, v1
    v_mov_b32 v7, s80
    s_sub_u32 s7, s81, 320
    v_mov_b32 v8, s7
    v_cndmask_b32 v7, v7, v8, vcc
    v_lshl_add_u32 v7, v1, 4, v7
    s_mul_i32 s70, s3, 320
    s_add_u32 s70, s70, 5308416
    s_mov_b32 s68, 0
    s_mov_b32 exec_hi, 0xff
    buffer_load_dwordx4 v[60:63], v7, s[44:47], s70 offen sc1
    s_mov_b32 exec_hi, -1
    ds_read_b64_tr_b16 a[0:1], v222 offset:0
    ds_read_b64_tr_b16 a[2:3], v222 offset:256
    ds_read_b64_tr_b16 a[4:5], v222 offset:32
    ds_read_b64_tr_b16 a[6:7], v222 offset:288
    ds_read_b64_tr_b16 a[8:9], v222 offset:2048
    ds_read_b64_tr_b16 a[10:11], v222 offset:2304
    ds_read_b64_tr_b16 a[12:13], v222 offset:2080
    ds_read_b64_tr_b16 a[14:15], v222 offset:2336
    ds_read_b64_tr_b16 a[16:17], v222 offset:4096
    ds_read_b64_tr_b16 a[18:19], v222 offset:4352
    ds_read_b64_tr_b16 a[20:21], v222 offset:4128
    ds_read_b64_tr_b16 a[22:23], v222 offset:4384
    ds_read_b64_tr_b16 a[24:25], v222 offset:6144
    ds_read_b64_tr_b16 a[26:27], v222 offset:6400
    ds_read_b64_tr_b16 a[28:29], v222 offset:6176
    ds_read_b64_tr_b16 a[30:31], v222 offset:6432
    ds_read_b64_tr_b16 a[32:33], v222 offset:8192
    ds_read_b64_tr_b16 a[34:35], v222 offset:8448
    ds_read_b64_tr_b16 a[36:37], v222 offset:8224
    ds_read_b64_tr_b16 a[38:39], v222 offset:8480
    ds_read_b64_tr_b16 a[40:41], v222 offset:10240
    ds_read_b64_tr_b16 a[42:43], v222 offset:10496
    ds_read_b64_tr_b16 a[44:45], v222 offset:10272
    ds_read_b64_tr_b16 a[46:47], v222 offset:10528
    ds_read_b64_tr_b16 a[48:49], v222 offset:12288
    ds_read_b64_tr_b16 a[50:51], v222 offset:12544
    ds_read_b64_tr_b16 a[52:53], v222 offset:12320
    ds_read_b64_tr_b16 a[54:55], v222 offset:12576
    ds_read_b64_tr_b16 a[56:57], v222 offset:14336
    ds_read_b64_tr_b16 a[58:59], v222 offset:14592
    ds_read_b64_tr_b16 a[60:61], v222 offset:14368
    ds_read_b64_tr_b16 a[62:63], v222 offset:14624
    ds_read_b64_tr_b16 a[64:65], v222 offset:16384
    ds_read_b64_tr_b16 a[66:67], v222 offset:16640
    ds_read_b64_tr_b16 a[68:69], v222 offset:16416
    ds_read_b64_tr_b16 a[70:71], v222 offset:16672
    ds_read_b64_tr_b16 a[72:73], v222 offset:18432
    ds_read_b64_tr_b16 a[74:75], v222 offset:18688
    ds_read_b64_tr_b16 a[76:77], v222 offset:18464
    ds_read_b64_tr_b16 a[78:79], v222 offset:18720
    s_mov_b32 exec_hi, 0xff
    s_branch L_xfirst
L_xpoll:
    buffer_load_dwordx4 v[60:63], v7, s[44:47], s70 offen sc1
L_xfirst:
    s_add_u32 s68, s68, 1
    s_cmp_gt_u32 s68, 400000
    s_waitcnt vmcnt(0)
    v_max3_u32 v2, v60, v61, v62
    v_max_u32 v2, v2, v63
    v_cmp_eq_u32 vcc, -1, v2
    s_cbranch_scc1 L_xpollx
    s_cbranch_vccnz L_xpoll
L_xpollx:
    ds_write_b128 v84, v[60:63]
    s_mov_b64 exec, -1
    ds_read_b128 v[40:43], v85 offset:0
    ds_read_b128 v[44:47], v85 offset:64
    ds_read_b128 v[48:51], v85 offset:128
    ds_read_b128 v[52:55], v85 offset:192
    ds_read_b128 v[56:59], v85 offset:256
    s_waitcnt lgkmcnt(4)
    v_mfma_f32_16x16x32_bf16 v[64:67], a[0:3], v[40:43], 0
    v_mfma_f32_16x16x32_bf16 v[72:75], a[40:43], v[40:43], 0
    v_mfma_f32_16x16x32_bf16 v[68:71], a[4:7], v[40:43], 0
    v_mfma_f32_16x16x32_bf16 v[76:79], a[44:47], v[40:43], 0
    s_waitcnt lgkmcnt(3)
    v_mfma_f32_16x16x32_bf16 v[64:67], a[8:11], v[44:47], v[64:67]
    v_mfma_f32_16x16x32_bf16 v[72:75], a[48:51], v[44:47], v[72:75]
    v_mfma_f32_16x16x32_bf16 v[68:71], a[12:15], v[44:47], v[68:71]
    v_mfma_f32_16x16x32_bf16 v[76:79], a[52:55], v[44:47], v[76:79]
    s_waitcnt lgkmcnt(2)
    v_mfma_f32_16x16x32_bf16 v[64:67], a[16:19], v[48:51], v[64:67]
    v_mfma_f32_16x16x32_bf16 v[72:75], a[56:59], v[48:51], v[72:75]
    v_mfma_f32_16x16x32_bf16 v[68:71], a[20:23], v[48:51], v[68:71]
    v_mfma_f32_16x16x32_bf16 v[76:79], a[60:63], v[48:51], v[76:79]
    s_waitcnt lgkmcnt(1)
    v_mfma_f32_16x16x32_bf16 v[64:67], a[24:27], v[52:55], v[64:67]
    v_mfma_f32_16x16x32_bf16 v[72:75], a[64:67], v[52:55], v[72:75]
    v_mfma_f32_16x16x32_bf16 v[68:71], a[28:31], v[52:55], v[68:71]
    v_mfma_f32_16x16x32_bf16 v[76:79], a[68:71], v[52:55], v[76:79]
    s_waitcnt lgkmcnt(0)
    v_mfma_f32_16x16x32_bf16 v[64:67], a[32:35], v[56:59], v[64:67]
    v_mfma_f32_16x16x32_bf16 v[72:75], a[72:75], v[56:59], v[72:75]
    v_mfma_f32_16x16x32_bf16 v[68:71], a[36:39], v[56:59], v[68:71]
    v_mfma_f32_16x16x32_bf16 v[76:79], a[76:79], v[56:59], v[76:79]
    s_mov_b32 exec_lo, 0x00030003
    s_mov_b32 exec_hi, 0x00030003
    s_nop 2
    ds_write_b128 v86, v[64:67]
    ds_write_b128 v86, v[72:75] offset:256
    ds_write_b128 v86, v[68:71] offset:64
    ds_write_b128 v86, v[76:79] offset:320
    s_mov_b64 exec, -1
    s_waitcnt lgkmcnt(0)
    s_barrier
    s_cmp_eq_u32 s3, 0
    s_cbranch_scc0 L_up_dflag
    ds_read2st64_b32 v[80:81], v87 offset0:0 offset1:1
    ds_read2st64_b32 v[82:83], v87 offset0:2 offset1:3
    ds_read2st64_b32 v[84:85], v87 offset0:4 offset1:5
    ds_read2st64_b32 v[86:87], v87 offset0:6 offset1:7
    s_lshl_b32 s7, s74, 7
    s_add_u32 s7, s7, 6619136
    v_lshlrev_b32 v6, 1, v1
    s_waitcnt lgkmcnt(2)
    v_pk_add_f32 v[80:81], v[80:81], v[82:83]
    s_waitcnt lgkmcnt(0)
    v_pk_add_f32 v[84:85], v[84:85], v[86:87]
    v_pk_add_f32 v[80:81], v[80:81], v[84:85]
    v_cvt_pk_bf16_f32 v80, v80, v81
    v_and_b32 v81, s6, v80
    v_lshlrev_b32 v80, 16, v80
    v_mul_f32 v82, -1.4426950408889634, v80
    v_exp_f32 v82, v82
    s_nop 0
    v_add_f32 v82, 1.0, v82
    v_rcp_f32 v82, v82
    s_nop 0
    v_mul_f32 v80, v80, v82
    v_cvt_pk_bf16_f32 v80, v80, v80
    v_lshlrev_b32 v80, 16, v80
    v_mul_f32 v80, v80, v81
    s_nop 1
    v_mov_b32_dpp v81, v80 quad_perm:[1,0,3,2] row_mask:0xf bank_mask:0xf
    v_cvt_pk_bf16_f32 v80, v80, v81
    s_mov_b32 exec_lo, 0x55555555
    s_mov_b32 exec_hi, 0x55555555
    buffer_store_dword v80, v6, s[44:47], s7 offen sc1
    s_mov_b64 exec, -1
    s_branch L_fin
L_down:
    ds_read_b64_tr_b16 a[0:1], v222 offset:0
    ds_read_b64_tr_b16 a[2:3], v222 offset:128
    ds_read_b64_tr_b16 a[4:5], v222 offset:1024
    ds_read_b64_tr_b16 a[6:7], v222 offset:1152
    ds_read_b64_tr_b16 a[8:9], v222 offset:2048
    ds_read_b64_tr_b16 a[10:11], v222 offset:2176
    ds_read_b64_tr_b16 a[12:13], v222 offset:3072
    ds_read_b64_tr_b16 a[14:15], v222 offset:3200
    ds_read_b64_tr_b16 a[16:17], v222 offset:4096
    ds_read_b64_tr_b16 a[18:19], v222 offset:4224
    ds_read_b64_tr_b16 a[20:21], v222 offset:5120
    ds_read_b64_tr_b16 a[22:23], v222 offset:5248
    ds_read_b64_tr_b16 a[24:25], v222 offset:6144
    ds_read_b64_tr_b16 a[26:27], v222 offset:6272
    ds_read_b64_tr_b16 a[28:29], v222 offset:7168
    ds_read_b64_tr_b16 a[30:31], v222 offset:7296
    ds_read_b64_tr_b16 a[32:33], v222 offset:8192
    ds_read_b64_tr_b16 a[34:35], v222 offset:8320
    ds_read_b64_tr_b16 a[36:37], v222 offset:9216
    ds_read_b64_tr_b16 a[38:39], v222 offset:9344
    ds_read_b64_tr_b16 a[40:41], v222 offset:10240
    ds_read_b64_tr_b16 a[42:43], v222 offset:10368
    ds_read_b64_tr_b16 a[44:45], v222 offset:11264
    ds_read_b64_tr_b16 a[46:47], v222 offset:11392
    s_waitcnt vmcnt(0)
    s_barrier
    s_lshl_b32 s7, s64, 7
    s_add_u32 s7, s7, 6684672
    s_cmp_eq_u32 s3, 0
    s_cselect_b32 s7, s7, 8388608
    v_mov_b32 v2, 1
    s_mov_b64 exec, 1
    buffer_store_dword v2, off, s[44:47], s7 sc1
    s_mov_b64 exec, -1
    s_or_b32 s69, s84, s3
    s_mov_b32 s7, 6881280
    s_cmp_eq_u32 s69, 0
    s_cselect_b32 s7, s7, 8388608
    v_mov_b32 v3, s92
    s_mov_b64 exec, 1
    buffer_store_dword v3, off, s[44:47], s7 sc1
    s_mov_b64 exec, -1
    s_cmp_eq_u32 s3, 0
    s_cbranch_scc0 L_nofin
    v_bfe_u32 v2, v1, 4, 1
    v_cmp_eq_u32 vcc, 1, v2
    v_mov_b32 v5, s78
    v_mov_b32 v6, s79
    v_cndmask_b32 v88, v5, v6, vcc
    v_mov_b32 v5, s80
    v_mov_b32 v6, s81
    v_cndmask_b32 v8, v5, v6, vcc
    v_mov_b32 v5, s82
    v_mov_b32 v6, s83
    v_cndmask_b32 v91, v5, v6, vcc
    v_lshrrev_b32 v9, 3, v88
    v_lshlrev_b32 v9, 7, v9
    s_mov_b32 s7, 6684672
    s_mov_b32 s68, 0
L_dpoll:
    buffer_load_dword v10, v9, s[44:47], s7 offen sc1
    s_add_u32 s68, s68, 1
    s_cmp_gt_u32 s68, 400000
    s_waitcnt vmcnt(0)
    s_cbranch_scc1 L_dpollx
    v_cmp_ne_u32 vcc, 1, v10
    s_cbranch_vccnz L_dpoll
L_dpollx:
    v_and_b32 v2, 15, v1
    s_lshl_b32 s7, s84, 5
    v_lshl_add_u32 v2, v2, 1, s7
    v_add_u32 v8, v8, v2
    s_mov_b32 s7, 5308416
    s_mov_b32 s69, 5963776
    buffer_load_ushort v89, v8, s[44:47], s7 offen sc1
    s_waitcnt vmcnt(0)
    buffer_load_ushort v90, v8, s[44:47], s69 offen sc1
    v_mul_u32_u24 v92, 1280, v88
    v_add_u32 v92, v92, v2
    v_not_b32 v5, v91
    v_ashrrev_i32 v5, 31, v5
    v_or_b32 v5, 0x80000000, v5
    v_xor_b32 v91, v91, v5
    v_and_b32 v91, s6, v91
    v_mul_f32 v91, -1.4426950408889634, v91
    v_exp_f32 v91, v91
    s_nop 0
    v_add_f32 v91, 1.0, v91
    v_rcp_f32 v91, v91
    s_nop 0
    v_cvt_pk_bf16_f32 v91, v91, v91
    v_lshlrev_b32 v91, 16, v91
    s_waitcnt vmcnt(0)
L_nofin:
    s_barrier
    v_lshlrev_b32 v7, 4, v1
    s_mul_i32 s70, s3, 1536
    s_add_u32 s71, s70, 103936
    v_add_u32 v8, s71, v7
    s_add_u32 s70, s70, 6619136
    v_and_b32 v2, 1, v1
    v_lshlrev_b32 v9, 6, v2
    v_lshrrev_b32 v2, 4, v1
    v_lshl_add_u32 v9, v2, 4, v9
    v_add_u32 v9, s71, v9
    v_cmp_gt_u32 vcc, 32, v1
    v_add_u32 v10, 1024, v7
    s_nop 0
    v_cndmask_b32 v10, v7, v10, vcc
    s_mov_b32 s68, 0
L_apoll:
    buffer_load_dwordx4 v[56:59], v7, s[44:47], s70 offen sc1
    buffer_load_dwordx4 v[60:63], v10, s[44:47], s70 offen sc1
    s_add_u32 s68, s68, 1
    s_cmp_gt_u32 s68, 400000
    s_waitcnt vmcnt(1)
    v_max3_u32 v2, v56, v57, v58
    s_waitcnt vmcnt(0)
    v_max3_u32 v2, v2, v59, v60
    v_max3_u32 v2, v2, v61, v62
    v_max_u32 v2, v2, v63
    v_cmp_eq_u32 vcc, -1, v2
    s_cbranch_scc1 L_apollx
    s_and_b64 exec, exec, vcc
    s_cbranch_execnz L_apoll
L_apollx:
    s_mov_b64 exec, -1
    ds_write_b128 v8, v[56:59]
    s_mov_b32 exec_hi, 0
    ds_write_b128 v8, v[60:63] offset:1024
    s_mov_b32 exec_hi, -1
    ds_read_b128 v[96:99], v9 offset:0
    ds_read_b128 v[100:103], v9 offset:128
    ds_read_b128 v[104:107], v9 offset:256
    ds_read_b128 v[108:111], v9 offset:384
    ds_read_b128 v[112:115], v9 offset:512
    ds_read_b128 v[116:119], v9 offset:640
    ds_read_b128 v[120:123], v9 offset:768
    ds_read_b128 v[124:127], v9 offset:896
    ds_read_b128 v[128:131], v9 offset:1024
    ds_read_b128 v[132:135], v9 offset:1152
    ds_read_b128 v[136:139], v9 offset:1280
    ds_read_b128 v[140:143], v9 offset:1408
    s_waitcnt lgkmcnt(11)
    v_mfma_f32_16x16x32_bf16 v[64:67], a[0:3], v[96:99], 0
    s_waitcnt lgkmcnt(10)
    v_mfma_f32_16x16x32_bf16 v[68:71], a[4:7], v[100:103], 0
    s_waitcnt lgkmcnt(9)
    v_mfma_f32_16x16x32_bf16 v[64:67], a[8:11], v[104:107], v[64:67]
    s_waitcnt lgkmcnt(8)
    v_mfma_f32_16x16x32_bf16 v[68:71], a[12:15], v[108:111], v[68:71]
    s_waitcnt lgkmcnt(7)
    v_mfma_f32_16x16x32_bf16 v[64:67], a[16:19], v[112:115], v[64:67]
    s_waitcnt lgkmcnt(6)
    v_mfma_f32_16x16x32_bf16 v[68:71], a[20:23], v[116:119], v[68:71]
    s_waitcnt lgkmcnt(5)
    v_mfma_f32_16x16x32_bf16 v[64:67], a[24:27], v[120:123], v[64:67]
    s_waitcnt lgkmcnt(4)
    v_mfma_f32_16x16x32_bf16 v[68:71], a[28:31], v[124:127], v[68:71]
    s_waitcnt lgkmcnt(3)
    v_mfma_f32_16x16x32_bf16 v[64:67], a[32:35], v[128:131], v[64:67]
    s_waitcnt lgkmcnt(2)
    v_mfma_f32_16x16x32_bf16 v[68:71], a[36:39], v[132:135], v[68:71]
    s_waitcnt lgkmcnt(1)
    v_mfma_f32_16x16x32_bf16 v[64:67], a[40:43], v[136:139], v[64:67]
    s_waitcnt lgkmcnt(0)
    v_mfma_f32_16x16x32_bf16 v[68:71], a[44:47], v[140:143], v[68:71]
    s_nop 7
    v_pk_add_f32 v[64:65], v[64:65], v[68:69]
    v_pk_add_f32 v[66:67], v[66:67], v[70:71]
    s_mov_b32 exec_lo, 0x00030003
    s_mov_b32 exec_hi, 0x00030003
    ds_write_b128 v93, v[64:67]
    s_mov_b64 exec, -1
    s_waitcnt lgkmcnt(0)
    s_barrier
    s_cmp_eq_u32 s3, 0
    s_cbranch_scc0 L_fin
    ds_read2_b32 v[80:81], v94 offset0:0 offset1:32
    ds_read2_b32 v[82:83], v94 offset0:64 offset1:96
    v_lshlrev_b32 v89, 16, v89
    v_lshlrev_b32 v90, 16, v90
    s_waitcnt lgkmcnt(0)
    v_pk_add_f32 v[80:81], v[80:81], v[82:83]
    v_add_f32 v80, v80, v81
    v_cvt_pk_bf16_f32 v80, v80, v80
    v_lshlrev_b32 v80, 16, v80
    v_mul_f32 v80, v80, v91
    v_cvt_pk_bf16_f32 v80, v80, v80
    v_lshlrev_b32 v80, 16, v80
    v_add_f32 v80, v80, v89
    v_cvt_pk_bf16_f32 v80, v80, v80
    v_lshlrev_b32 v80, 16, v80
    v_add_f32 v80, v80, v90
    s_nop 1
    v_mov_b32_dpp v81, v80 quad_perm:[1,0,3,2] row_mask:0xf bank_mask:0xf
    v_cvt_pk_bf16_f32 v80, v80, v81
    s_mov_b32 exec_lo, 0x55555555
    s_mov_b32 exec_hi, 0
    buffer_store_dword v80, v92, s[52:55], 0 offen sc1
    s_mov_b64 exec, -1
L_fin:
L_end:
    s_endpgm
L_f0a_slow:
    s_mov_b32 s68, 0
L_f0a_loop:
    buffer_load_dword v110, v12, s[44:47], s10 offen sc1
    s_add_u32 s68, s68, 1
    s_cmp_gt_u32 s68, 400000
    s_cbranch_scc1 L_f0a_ok
    s_waitcnt vmcnt(0)
    v_cmp_ne_u32 vcc, s92, v110
    s_cbranch_vccnz L_f0a_loop
    s_branch L_f0a_ok
L_ua_slow:
    s_mov_b32 s68, 0
L_ua_loop:
    s_mov_b64 exec, vcc
    buffer_load_dwordx4 v[164:167], v14, s[44:47], s11 offen offset:0 sc1
    buffer_load_dwordx4 v[168:171], v14, s[44:47], s11 offen offset:1024 sc1
    s_add_u32 s68, s68, 1
    s_cmp_gt_u32 s68, 400000
    s_waitcnt vmcnt(0)
    v_max3_u32 v2, v164, v165, v166
    v_max3_u32 v2, v2, v167, v168
    v_max3_u32 v2, v2, v169, v170
    v_max_u32 v2, v2, v171
    v_cmp_eq_u32 vcc, -1, v2
    s_mov_b64 exec, -1
    s_cbranch_scc1 L_ua_ok
    s_cbranch_vccnz L_ua_loop
    s_branch L_ua_ok
L_ub_slow:
    s_mov_b32 s68, 0
L_ub_loop:
    s_mov_b64 exec, vcc
    buffer_load_dwordx4 v[172:175], v14, s[44:47], s11 offen offset:2048 sc1
    buffer_load_dwordx4 v[176:179], v14, s[44:47], s11 offen offset:3072 sc1
    s_add_u32 s68, s68, 1
    s_cmp_gt_u32 s68, 400000
    s_waitcnt vmcnt(0)
    v_max3_u32 v2, v172, v173, v174
    v_max3_u32 v2, v2, v175, v176
    v_max3_u32 v2, v2, v177, v178
    v_max_u32 v2, v2, v179
    v_cmp_eq_u32 vcc, -1, v2
    s_mov_b64 exec, -1
    s_cbranch_scc1 L_ub_ok
    s_cbranch_vccnz L_ub_loop
    s_branch L_ub_ok
L_up_dflag:
    s_lshl_b32 s7, s64, 7
    s_add_u32 s7, s7, 6684672
    s_cmp_eq_u32 s3, 1
    s_cselect_b32 s7, s7, 8388608
    v_mov_b32 v2, 1
    s_mov_b64 exec, 1
    buffer_store_dword v2, off, s[44:47], s7 sc1
    s_mov_b64 exec, -1
    s_branch L_fin
L_yretry:
    s_mov_b64 exec, vcc
    s_cmp_lt_u32 s2, 160
    s_cbranch_scc1 L_ypoll
    s_sleep 4
    s_branch L_ypoll
L_code_end:
.section .rodata,"a"
.p2align 6
.amdhsa_kernel sequential_preLN__ssm_conv_h3__moe_arch_mod__prompt_kernel
  .amdhsa_next_free_vgpr 512
  .amdhsa_next_free_sgpr 102
  .amdhsa_accum_offset 256
  .amdhsa_group_segment_fixed_size 0
  .amdhsa_kernarg_size 112
  .amdhsa_user_sgpr_count 2
  .amdhsa_user_sgpr_kernarg_segment_ptr 1
  .amdhsa_system_sgpr_workgroup_id_x 1
  .amdhsa_float_denorm_mode_32 3
.end_amdhsa_kernel
```
